```python
import torch

def _softmax(x, axis=-1):
    return torch.softmax(x, dim=axis)
def _gelu(x):
    return torch.nn.functional.gelu(x, approximate="tanh")
def _silu(x):
    return torch.nn.functional.silu(x)
def _sigmoid(x):
    return torch.sigmoid(x)
def _layernorm(x, axis=-1, eps=1e-5):
    m = x.mean(dim=axis, keepdim=True)
    v = x.var(dim=axis, keepdim=True, unbiased=False)
    return (x - m) / torch.sqrt(v + eps)
def _scatter_add(tgt, idx, src, axis=0):
    return tgt.clone().index_add_(axis, idx, src)
def _segment_sum(src, seg, n):
    out = torch.zeros((n,) + src.shape[1:], dtype=src.dtype)
    return out.index_add_(0, seg, src)
def _pad(x, pw):
    flat = tuple(v for pair in reversed(pw) for v in pair)
    return torch.nn.functional.pad(x, flat)

kernel_name = 'concat_heads__ssm_conv_h3__softmax_full_mha__prompt'

def setup_inputs():

    _w = (lambda a: (lambda t: t.to(torch.bfloat16) if t.is_floating_point() else t)(torch.as_tensor(a)))
    def _A_setup():
        B, S, D = 1, 2048, 512
        ks = 4
        return {
            "q": _w((lambda *s: torch.randn(*s, dtype=torch.bfloat16) * 0.05)(B, S, D)),
            "k": _w((lambda *s: torch.randn(*s, dtype=torch.bfloat16) * 0.4)(B, S, D)),
            "v": _w((lambda *s: torch.randn(*s, dtype=torch.bfloat16) * 0.4)(B, S, D)),
            "shift_k": _w((lambda *s: torch.randn(*s, dtype=torch.bfloat16) * 0.4)(D, ks) * 0.5),
            "ssm_k": _w((lambda *s: torch.randn(*s, dtype=torch.bfloat16) * 1.6)(D, S) * (1.0 / S ** 0.5)),
            "ssm_D": _w((lambda *s: torch.randn(*s, dtype=torch.bfloat16) * 0.4)(D)),
        }
    _A_in = _A_setup()

    def _B_setup():
        B, S, D = 1, 2048, 512
        return {
            "x": _w((lambda *s: torch.randn(*s, dtype=torch.bfloat16) * 0.2)(B, S, D)),
            "wqkv": _w((lambda *s: torch.randn(*s, dtype=torch.bfloat16) * 0.2)(D, 3 * D)),
            "wo": _w((lambda *s: torch.randn(*s, dtype=torch.bfloat16) * 0.05)(D, D)),
        }
    _B_in = _B_setup()

    return {
        "A_q": _A_in["q"],
        "A_k": _A_in["k"],
        "A_v": _A_in["v"],
        "A_shift_k": _A_in["shift_k"],
        "A_ssm_k": _A_in["ssm_k"],
        "A_ssm_D": _A_in["ssm_D"],
        "B_x": _B_in["x"],
        "B_wqkv": _B_in["wqkv"],
        "B_wo": _B_in["wo"],
    }

def reference(A_q, A_k, A_v, A_shift_k, A_ssm_k, A_ssm_D, B_x, B_wqkv, B_wo):
    def _A_ref(q, k, v, shift_k, ssm_k, ssm_D):
        B, S, D = q.shape
        ks = shift_k.shape[-1]
        k_pad = _pad(k, ((0, 0), (ks - 1, 0), (0, 0)))
        k_shift = torch.zeros_like(k)
        for t in range(ks):
            k_shift = k_shift + k_pad[:, t:t + S, :] * shift_k[:, ks - 1 - t][None, None, :]
        kv = k_shift * v
        L = 2 * S
        kv_pad = _pad(kv, ((0, 0), (0, S), (0, 0)))
        kf_pad = _pad(ssm_k, ((0, 0), (0, S)))
        kv_f = (lambda x, axes=(-2,-1): torch.fft.rfft2(x.float(), dim=axes))(kv_pad[:, None, :, :], axes=(1, 2))
        kf_f = (lambda x, axes=(-2,-1): torch.fft.rfft2(x.float(), dim=axes))(kf_pad[:, None, :], axes=(1, 2))
        kf_f = (lambda x, *d: x.permute(*d))(kf_f, 1, 2, 0)
        y_f = kv_f * kf_f[None, :, :, :]
        y = (lambda x, s, axes=(-2,-1): torch.fft.irfft2(x, s=s, dim=axes).to(torch.bfloat16))(y_f, (1, L), axes=(1, 2))[:, 0, :S, :]
        y = y + kv * ssm_D[None, None, :]
        return q * y

    def _B_ref(x, wqkv, wo):
        B, S, D = x.shape
        H = 32; Dh = D // H
        qkv = (lambda x, *d: x.permute(*d))((x @ wqkv).reshape(B, S, 3, H, Dh), 2, 0, 3, 1, 4)
        q, k, v = qkv[0], qkv[1], qkv[2]
        scale = Dh ** -0.5
        scores = torch.einsum("bhqd,bhkd->bhqk", q, k) * scale
        p = _softmax(scores, axis=-1)
        o = torch.einsum("bhqk,bhkd->bhqd", p, v)
        return (lambda x, *d: x.permute(*d))(o, 0, 2, 1, 3).reshape(B, S, D) @ wo

    a = _A_ref(A_q, A_k, A_v, A_shift_k, A_ssm_k, A_ssm_D)
    b = _B_ref(B_x, B_wqkv, B_wo)
    return torch.concatenate([a, b], axis=-1)
```

```asm
; @launch grid=(256,1,1) block=(768,1,1) lds=163408
.amdgcn_target "amdgcn-amd-amdhsa--gfx950"
.text
.globl concat_heads__ssm_conv_h3__softmax_full_mha__prompt_kernel
.p2align 8
.type concat_heads__ssm_conv_h3__softmax_full_mha__prompt_kernel,@function
concat_heads__ssm_conv_h3__softmax_full_mha__prompt_kernel:
    s_cmp_ge_u32 s2, 256
    s_cbranch_scc1 end_1
    s_load_dwordx16 s[36:51], s[0:1], 0
    s_load_dwordx8 s[52:59], s[0:1], 64
    v_lshrrev_b32 v1, 6, v0
    v_and_b32 v2, 63, v0
    s_and_b32 s62, s2, 7
    v_readfirstlane_b32 s3, v1
    s_lshr_b32 s63, s2, 3
    s_and_b32 s64, s62, 3
    s_lshl_b32 s64, s64, 3
    s_and_b32 s67, s63, 7
    s_add_u32 s64, s64, s67
    s_lshr_b32 s65, s62, 2
    s_lshl_b32 s65, s65, 2
    s_lshr_b32 s68, s63, 3
    s_add_u32 s65, s65, s68
    s_lshl_b32 s66, s62, 2
    s_add_u32 s66, s66, s68
    s_mov_b32 s64, s63
    s_mov_b32 s65, s62
    v_lshlrev_b32 v3, 4, v2
    s_cmp_ge_u32 s3, 8
    s_cbranch_scc1 xw_2
    v_mov_b32 v122, -1
    v_mov_b32 v123, -1
    s_cmp_lt_u32 s3, 4
    s_cbranch_scc1 nokv_6
    s_setprio 3
    s_and_b32 s75, s3, 3
    s_lshl_b32 s76, s63, 2
    s_add_u32 s76, s76, s75
    s_lshl_b32 s77, s76, 14
    s_lshl_b32 s78, s62, 7
    s_add_u32 s77, s77, s78
    v_lshrrev_b32 v112, 3, v2
    v_lshlrev_b32 v112, 10, v112
    v_and_b32 v113, 7, v2
    v_lshl_add_u32 v112, v113, 4, v112
    v_add_u32 v112, s77, v112
    v_subrev_u32 v113, 0x1000, v112
    v_add_u32 v114, 0x1000, v112
    v_add_u32 v115, 0x3000, v112
    v_add_u32 v116, 0x2000, v112
    s_mul_i32 s79, s75, 4608
    s_add_u32 s79, s79, 132096
    s_lshl_b32 s78, s62, 6
    v_add_u32 v119, s78, v2
    v_lshlrev_b32 v120, 3, v119
    s_mov_b32 m0, s79
    s_waitcnt lgkmcnt(0)
    s_mov_b32 s16, s38
    s_mov_b32 s17, s39
    s_mov_b32 s18, 0x200000
    s_mov_b32 s19, 0x00020000
    s_mov_b32 s20, s40
    s_mov_b32 s21, s41
    s_mov_b32 s22, 0x200000
    s_mov_b32 s23, 0x00020000
    s_mov_b32 s24, s42
    s_mov_b32 s25, s43
    s_mov_b32 s26, 0x1000
    s_mov_b32 s27, 0x00020000
    buffer_load_dwordx4 v113, s[16:19], 0 offen lds
    s_add_u32 m0, s79, 1024
    s_nop 0
    buffer_load_dwordx4 v114, s[16:19], 0 offen lds
    s_add_u32 m0, s79, 2048
    s_mov_b32 exec_hi, 0
    buffer_load_dwordx4 v115, s[16:19], 0 offen lds
    s_mov_b32 exec_hi, -1
    s_add_u32 m0, s79, 2560
    s_nop 0
    buffer_load_dwordx4 v112, s[20:23], 0 offen lds
    s_add_u32 m0, s79, 3584
    s_nop 0
    buffer_load_dwordx4 v116, s[20:23], 0 offen lds
    buffer_load_dwordx2 v[124:125], v120, s[24:27], 0 offen
    s_barrier
    v_bfe_u32 v121, v2, 2, 2
    v_lshlrev_b32 v121, 7, v121
    v_lshrrev_b32 v122, 4, v2
    v_lshl_add_u32 v121, v122, 5, v121
    v_and_b32 v122, 3, v2
    v_lshl_add_u32 v121, v122, 3, v121
    v_add_u32 v121, s79, v121
    s_lshl_b32 s76, s76, 1
    s_sub_u32 s76, 254, s76
    s_lshl_b32 s76, s76, 13
    s_add_u32 s76, s76, 0x600000
    v_lshlrev_b32 v122, 4, v119
    v_add_u32 v122, s76, v122
    v_add_u32 v123, 0x2000, v122
    s_branch nokv2_7
nokv_6:
    v_lshlrev_b32 v9, 2, v2
    v_add_u32 v9, 163280, v9
    v_mov_b32 v10, 0
    s_mov_b32 exec_hi, 0
    ds_write_b32 v9, v10
    s_mov_b32 exec_hi, -1
    s_lshl_b32 s75, s2, 4
    s_add_u32 s75, s75, s3
    s_cmp_lg_u32 s75, 16
    s_cbranch_scc1 nn_8
    s_memrealtime s[78:79]
    s_waitcnt lgkmcnt(0)
    s_mov_b32 s28, s56
    s_mov_b32 s29, s57
    s_mov_b32 s30, 0x100
    s_mov_b32 s31, 0x00020000
    s_or_b32 s78, s78, 1
    v_mov_b32 v12, s78
    v_mov_b32 v13, s79
    s_mov_b64 exec, 1
    buffer_store_dwordx2 v[12:13], v10, s[28:31], 0 offen sc1
    s_mov_b64 exec, -1
nn_8:
    s_waitcnt lgkmcnt(0)
    s_barrier
nokv2_7:
    s_and_b32 s68, s3, 1
    s_bfe_u32 s69, s3, 0x10001
    v_and_b32 v4, 31, v2
    v_lshrrev_b32 v5, 5, v2
    s_lshl_b32 s70, s68, 12
    v_lshlrev_b32 v6, 7, v4
    v_add_u32 v6, s70, v6
    v_bfe_u32 v7, v4, 1, 3
    v_xor_b32 v7, v7, v5
    v_lshlrev_b32 v7, 4, v7
    v_add_u32 v100, v6, v7
    v_xor_b32 v101, 32, v100
    v_xor_b32 v102, 64, v100
    v_xor_b32 v103, 0x60, v100
    v_bfe_u32 v6, v2, 2, 2
    v_lshl_add_u32 v6, v5, 3, v6
    v_lshlrev_b32 v6, 7, v6
    v_bfe_u32 v7, v2, 3, 1
    v_xor_b32 v7, s69, v7
    v_lshl_add_u32 v6, v7, 6, v6
    v_bfe_u32 v7, v2, 4, 1
    v_lshl_add_u32 v6, v7, 5, v6
    v_and_b32 v7, 3, v2
    v_lshl_add_u32 v6, v7, 3, v6
    v_add_u32 v104, 65536, v6
    v_add_u32 v105, 131072, v6
    v_mov_b32 v16, 0
    v_mov_b32 v17, 0
    v_mov_b32 v18, 0
    v_mov_b32 v19, 0
    v_mov_b32 v20, 0
    v_mov_b32 v21, 0
    v_mov_b32 v22, 0
    v_mov_b32 v23, 0
    v_mov_b32 v24, 0
    v_mov_b32 v25, 0
    v_mov_b32 v26, 0
    v_mov_b32 v27, 0
    v_mov_b32 v28, 0
    v_mov_b32 v29, 0
    v_mov_b32 v30, 0
    v_mov_b32 v31, 0
    v_mov_b32 v32, 0
    v_mov_b32 v33, 0
    v_mov_b32 v34, 0
    v_mov_b32 v35, 0
    v_mov_b32 v36, 0
    v_mov_b32 v37, 0
    v_mov_b32 v38, 0
    v_mov_b32 v39, 0
    v_mov_b32 v40, 0
    v_mov_b32 v41, 0
    v_mov_b32 v42, 0
    v_mov_b32 v43, 0
    v_mov_b32 v44, 0
    v_mov_b32 v45, 0
    v_mov_b32 v46, 0
    v_mov_b32 v47, 0
    s_lshl_b32 s70, s64, 1
    s_add_u32 s68, s68, s70
    s_lshl_b32 s70, s65, 1
    s_add_u32 s69, s69, s70
    s_lshl_b32 s70, s69, 17
    s_lshl_b32 s71, s68, 10
    s_add_u32 s70, s70, s71
    s_add_u32 s71, s70, 0x10000
    s_lshl_b32 s72, s69, 18
    s_lshl_b32 s73, s68, 11
    s_add_u32 s72, s72, s73
    s_add_u32 s72, s72, 0x200000
    s_add_u32 s73, s72, 0x20000
    s_lshl_b32 s74, s65, 5
    s_add_u32 s74, s74, s64
    s_lshl_b32 s74, s74, 3
    s_mov_b32 s77, 0
    s_add_u32 s76, s74, 0xc02000
    s_add_u32 s74, s74, 0xc00000
    s_waitcnt lgkmcnt(0)
    s_mov_b32 s4, s58
    s_mov_b32 s5, s59
    s_mov_b32 s6, 0xc10000
    s_mov_b32 s7, 0x00020000
    s_cmp_ge_u32 s3, 4
    s_cbranch_scc1 g1_3
    v_and_b32 v6, 0x33, v2
    v_bfe_u32 v7, v2, 2, 1
    v_lshl_add_u32 v6, v7, 3, v6
    v_bfe_u32 v7, v2, 3, 1
    v_lshl_add_u32 v6, v7, 2, v6
    v_lshlrev_b32 v6, 4, v6
    s_mov_b32 s75, 0x3eb8aa3b
    s_barrier
    ds_read_b128 v[48:51], v100 offset:0
    ds_read_b64_tr_b16 v[52:53], v104 offset:0
    ds_read_b64_tr_b16 v[54:55], v104 offset:512
    ds_read_b128 v[56:59], v101 offset:0
    ds_read_b64_tr_b16 v[60:61], v104 offset:2048
    ds_read_b64_tr_b16 v[62:63], v104 offset:2560
    ds_read_b128 v[64:67], v102 offset:0
    ds_read_b64_tr_b16 v[68:69], v104 offset:4096
    ds_read_b64_tr_b16 v[70:71], v104 offset:4608
    ds_read_b128 v[72:75], v103 offset:0
    ds_read_b64_tr_b16 v[76:77], v104 offset:6144
    ds_read_b64_tr_b16 v[78:79], v104 offset:6656
    s_waitcnt lgkmcnt(9)
    v_mfma_f32_32x32x16_bf16 v[16:31], v[52:55], v[48:51], v[16:31]
    s_waitcnt lgkmcnt(0)
    s_barrier
    ds_read_b128 v[48:51], v100 offset:8192
    ds_read_b64_tr_b16 v[52:53], v104 offset:16384
    ds_read_b64_tr_b16 v[54:55], v104 offset:16896
    s_waitcnt lgkmcnt(9)
    v_mfma_f32_32x32x16_bf16 v[16:31], v[60:63], v[56:59], v[16:31]
    ds_read_b128 v[56:59], v101 offset:8192
    ds_read_b64_tr_b16 v[60:61], v104 offset:18432
    ds_read_b64_tr_b16 v[62:63], v104 offset:18944
    s_waitcnt lgkmcnt(9)
    v_mfma_f32_32x32x16_bf16 v[16:31], v[68:71], v[64:67], v[16:31]
    ds_read_b128 v[64:67], v102 offset:8192
    ds_read_b64_tr_b16 v[68:69], v104 offset:20480
    ds_read_b64_tr_b16 v[70:71], v104 offset:20992
    s_waitcnt lgkmcnt(9)
    v_mfma_f32_32x32x16_bf16 v[16:31], v[76:79], v[72:75], v[16:31]
    ds_read_b128 v[72:75], v103 offset:8192
    ds_read_b64_tr_b16 v[76:77], v104 offset:22528
    ds_read_b64_tr_b16 v[78:79], v104 offset:23040
    s_waitcnt lgkmcnt(9)
    v_mfma_f32_32x32x16_bf16 v[16:31], v[52:55], v[48:51], v[16:31]
    s_waitcnt lgkmcnt(0)
    s_barrier
    ds_read_b128 v[48:51], v100 offset:16384
    ds_read_b64_tr_b16 v[52:53], v104 offset:32768
    ds_read_b64_tr_b16 v[54:55], v104 offset:33280
    s_waitcnt lgkmcnt(9)
    v_mfma_f32_32x32x16_bf16 v[16:31], v[60:63], v[56:59], v[16:31]
    ds_read_b128 v[56:59], v101 offset:16384
    ds_read_b64_tr_b16 v[60:61], v104 offset:34816
    ds_read_b64_tr_b16 v[62:63], v104 offset:35328
    s_waitcnt lgkmcnt(9)
    v_mfma_f32_32x32x16_bf16 v[16:31], v[68:71], v[64:67], v[16:31]
    ds_read_b128 v[64:67], v102 offset:16384
    ds_read_b64_tr_b16 v[68:69], v104 offset:36864
    ds_read_b64_tr_b16 v[70:71], v104 offset:37376
    s_waitcnt lgkmcnt(9)
    v_mfma_f32_32x32x16_bf16 v[16:31], v[76:79], v[72:75], v[16:31]
    ds_read_b128 v[72:75], v103 offset:16384
    ds_read_b64_tr_b16 v[76:77], v104 offset:38912
    ds_read_b64_tr_b16 v[78:79], v104 offset:39424
    s_waitcnt lgkmcnt(9)
    v_mfma_f32_32x32x16_bf16 v[16:31], v[52:55], v[48:51], v[16:31]
    s_waitcnt lgkmcnt(0)
    s_barrier
    ds_read_b128 v[48:51], v100 offset:24576
    ds_read_b64_tr_b16 v[52:53], v104 offset:49152
    ds_read_b64_tr_b16 v[54:55], v104 offset:49664
    s_waitcnt lgkmcnt(9)
    v_mfma_f32_32x32x16_bf16 v[16:31], v[60:63], v[56:59], v[16:31]
    ds_read_b128 v[56:59], v101 offset:24576
    ds_read_b64_tr_b16 v[60:61], v104 offset:51200
    ds_read_b64_tr_b16 v[62:63], v104 offset:51712
    s_waitcnt lgkmcnt(9)
    v_mfma_f32_32x32x16_bf16 v[16:31], v[68:71], v[64:67], v[16:31]
    ds_read_b128 v[64:67], v102 offset:24576
    ds_read_b64_tr_b16 v[68:69], v104 offset:53248
    ds_read_b64_tr_b16 v[70:71], v104 offset:53760
    s_waitcnt lgkmcnt(9)
    v_mfma_f32_32x32x16_bf16 v[16:31], v[76:79], v[72:75], v[16:31]
    ds_read_b128 v[72:75], v103 offset:24576
    ds_read_b64_tr_b16 v[76:77], v104 offset:55296
    ds_read_b64_tr_b16 v[78:79], v104 offset:55808
    s_waitcnt lgkmcnt(9)
    v_mfma_f32_32x32x16_bf16 v[16:31], v[52:55], v[48:51], v[16:31]
    s_waitcnt lgkmcnt(0)
    s_barrier
    ds_read_b128 v[48:51], v100 offset:32768
    ds_read_b64_tr_b16 v[52:53], v104 offset:0
    ds_read_b64_tr_b16 v[54:55], v104 offset:512
    s_waitcnt lgkmcnt(9)
    v_mfma_f32_32x32x16_bf16 v[16:31], v[60:63], v[56:59], v[16:31]
    ds_read_b128 v[56:59], v101 offset:32768
    ds_read_b64_tr_b16 v[60:61], v104 offset:2048
    ds_read_b64_tr_b16 v[62:63], v104 offset:2560
    s_waitcnt lgkmcnt(9)
    v_mfma_f32_32x32x16_bf16 v[16:31], v[68:71], v[64:67], v[16:31]
    ds_read_b128 v[64:67], v102 offset:32768
    ds_read_b64_tr_b16 v[68:69], v104 offset:4096
    ds_read_b64_tr_b16 v[70:71], v104 offset:4608
    s_waitcnt lgkmcnt(9)
    v_mfma_f32_32x32x16_bf16 v[16:31], v[76:79], v[72:75], v[16:31]
    ds_read_b128 v[72:75], v103 offset:32768
    ds_read_b64_tr_b16 v[76:77], v104 offset:6144
    ds_read_b64_tr_b16 v[78:79], v104 offset:6656
    s_waitcnt lgkmcnt(9)
    v_mfma_f32_32x32x16_bf16 v[16:31], v[52:55], v[48:51], v[16:31]
    s_waitcnt lgkmcnt(0)
    s_barrier
    ds_read_b128 v[48:51], v100 offset:40960
    ds_read_b64_tr_b16 v[52:53], v104 offset:16384
    ds_read_b64_tr_b16 v[54:55], v104 offset:16896
    s_waitcnt lgkmcnt(9)
    v_mfma_f32_32x32x16_bf16 v[16:31], v[60:63], v[56:59], v[16:31]
    ds_read_b128 v[56:59], v101 offset:40960
    ds_read_b64_tr_b16 v[60:61], v104 offset:18432
    ds_read_b64_tr_b16 v[62:63], v104 offset:18944
    s_waitcnt lgkmcnt(9)
    v_mfma_f32_32x32x16_bf16 v[16:31], v[68:71], v[64:67], v[16:31]
    ds_read_b128 v[64:67], v102 offset:40960
    ds_read_b64_tr_b16 v[68:69], v104 offset:20480
    ds_read_b64_tr_b16 v[70:71], v104 offset:20992
    s_waitcnt lgkmcnt(9)
    v_mfma_f32_32x32x16_bf16 v[16:31], v[76:79], v[72:75], v[16:31]
    ds_read_b128 v[72:75], v103 offset:40960
    ds_read_b64_tr_b16 v[76:77], v104 offset:22528
    ds_read_b64_tr_b16 v[78:79], v104 offset:23040
    s_waitcnt lgkmcnt(9)
    v_mfma_f32_32x32x16_bf16 v[16:31], v[52:55], v[48:51], v[16:31]
    s_waitcnt lgkmcnt(0)
    s_barrier
    ds_read_b128 v[48:51], v100 offset:49152
    ds_read_b64_tr_b16 v[52:53], v104 offset:32768
    ds_read_b64_tr_b16 v[54:55], v104 offset:33280
    s_waitcnt lgkmcnt(9)
    v_mfma_f32_32x32x16_bf16 v[16:31], v[60:63], v[56:59], v[16:31]
    ds_read_b128 v[56:59], v101 offset:49152
    ds_read_b64_tr_b16 v[60:61], v104 offset:34816
    ds_read_b64_tr_b16 v[62:63], v104 offset:35328
    s_waitcnt lgkmcnt(9)
    v_mfma_f32_32x32x16_bf16 v[16:31], v[68:71], v[64:67], v[16:31]
    ds_read_b128 v[64:67], v102 offset:49152
    ds_read_b64_tr_b16 v[68:69], v104 offset:36864
    ds_read_b64_tr_b16 v[70:71], v104 offset:37376
    s_waitcnt lgkmcnt(9)
    v_mfma_f32_32x32x16_bf16 v[16:31], v[76:79], v[72:75], v[16:31]
    ds_read_b128 v[72:75], v103 offset:49152
    ds_read_b64_tr_b16 v[76:77], v104 offset:38912
    ds_read_b64_tr_b16 v[78:79], v104 offset:39424
    s_waitcnt lgkmcnt(9)
    v_mfma_f32_32x32x16_bf16 v[16:31], v[52:55], v[48:51], v[16:31]
    s_waitcnt lgkmcnt(0)
    s_barrier
    ds_read_b128 v[48:51], v100 offset:57344
    ds_read_b64_tr_b16 v[52:53], v104 offset:49152
    ds_read_b64_tr_b16 v[54:55], v104 offset:49664
    s_waitcnt lgkmcnt(9)
    v_mfma_f32_32x32x16_bf16 v[16:31], v[60:63], v[56:59], v[16:31]
    ds_read_b128 v[56:59], v101 offset:57344
    ds_read_b64_tr_b16 v[60:61], v104 offset:51200
    ds_read_b64_tr_b16 v[62:63], v104 offset:51712
    s_waitcnt lgkmcnt(9)
    v_mfma_f32_32x32x16_bf16 v[16:31], v[68:71], v[64:67], v[16:31]
    ds_read_b128 v[64:67], v102 offset:57344
    ds_read_b64_tr_b16 v[68:69], v104 offset:53248
    ds_read_b64_tr_b16 v[70:71], v104 offset:53760
    s_waitcnt lgkmcnt(9)
    v_mfma_f32_32x32x16_bf16 v[16:31], v[76:79], v[72:75], v[16:31]
    ds_read_b128 v[72:75], v103 offset:57344
    ds_read_b64_tr_b16 v[76:77], v104 offset:55296
    ds_read_b64_tr_b16 v[78:79], v104 offset:55808
    s_waitcnt lgkmcnt(9)
    v_mfma_f32_32x32x16_bf16 v[16:31], v[52:55], v[48:51], v[16:31]
    s_waitcnt lgkmcnt(6)
    v_mfma_f32_32x32x16_bf16 v[16:31], v[60:63], v[56:59], v[16:31]
    s_waitcnt lgkmcnt(3)
    v_mfma_f32_32x32x16_bf16 v[16:31], v[68:71], v[64:67], v[16:31]
    s_waitcnt lgkmcnt(0)
    v_mfma_f32_32x32x16_bf16 v[16:31], v[76:79], v[72:75], v[16:31]
    s_setprio 3
    s_nop 10
    v_cvt_pk_bf16_f32 v80, v16, v17
    v_cvt_pk_bf16_f32 v81, v18, v19
    v_cvt_pk_bf16_f32 v82, v20, v21
    v_cvt_pk_bf16_f32 v83, v22, v23
    v_cvt_pk_bf16_f32 v84, v24, v25
    v_cvt_pk_bf16_f32 v85, v26, v27
    v_cvt_pk_bf16_f32 v86, v28, v29
    v_cvt_pk_bf16_f32 v87, v30, v31
    buffer_store_dwordx4 v[80:83], v6, s[4:7], s72 offen sc1
    buffer_store_dwordx4 v[84:87], v6, s[4:7], s73 offen sc1
    v_mov_b32 v8, 163280
    s_mov_b32 s79, 0
lw_9:
    ds_read_b32 v9, v8 offset:92
    s_add_u32 s79, s79, 1
    s_waitcnt lgkmcnt(0)
    v_cmp_le_u32 vcc, 8, v9
    s_cmp_gt_u32 s79, 480000
    s_cbranch_scc1 lg_10
    s_cbranch_vccnz lg_10
    s_branch lw_9
lg_10:
    ds_read_b128 v[48:51], v100 offset:0
    ds_read_b64_tr_b16 v[52:53], v105 offset:0
    ds_read_b64_tr_b16 v[54:55], v105 offset:512
    ds_read_b128 v[56:59], v101 offset:0
    ds_read_b64_tr_b16 v[60:61], v105 offset:2048
    ds_read_b64_tr_b16 v[62:63], v105 offset:2560
    ds_read_b128 v[64:67], v102 offset:0
    ds_read_b64_tr_b16 v[68:69], v105 offset:4096
    ds_read_b64_tr_b16 v[70:71], v105 offset:4608
    ds_read_b128 v[72:75], v103 offset:0
    ds_read_b64_tr_b16 v[76:77], v105 offset:6144
    ds_read_b64_tr_b16 v[78:79], v105 offset:6656
    s_waitcnt lgkmcnt(9)
    v_mfma_f32_32x32x16_bf16 v[32:47], v[52:55], v[48:51], v[32:47]
    ds_read_b128 v[48:51], v100 offset:8192
    ds_read_b64_tr_b16 v[52:53], v105 offset:8192
    ds_read_b64_tr_b16 v[54:55], v105 offset:8704
    s_waitcnt lgkmcnt(9)
    v_mfma_f32_32x32x16_bf16 v[32:47], v[60:63], v[56:59], v[32:47]
    ds_read_b128 v[56:59], v101 offset:8192
    ds_read_b64_tr_b16 v[60:61], v105 offset:10240
    ds_read_b64_tr_b16 v[62:63], v105 offset:10752
    s_waitcnt lgkmcnt(9)
    v_mfma_f32_32x32x16_bf16 v[32:47], v[68:71], v[64:67], v[32:47]
    ds_read_b128 v[64:67], v102 offset:8192
    ds_read_b64_tr_b16 v[68:69], v105 offset:12288
    ds_read_b64_tr_b16 v[70:71], v105 offset:12800
    s_waitcnt lgkmcnt(9)
    v_mfma_f32_32x32x16_bf16 v[32:47], v[76:79], v[72:75], v[32:47]
    ds_read_b128 v[72:75], v103 offset:8192
    ds_read_b64_tr_b16 v[76:77], v105 offset:14336
    ds_read_b64_tr_b16 v[78:79], v105 offset:14848
    s_waitcnt lgkmcnt(9)
    v_mfma_f32_32x32x16_bf16 v[32:47], v[52:55], v[48:51], v[32:47]
    ds_read_b128 v[48:51], v100 offset:16384
    ds_read_b64_tr_b16 v[52:53], v104 offset:0
    ds_read_b64_tr_b16 v[54:55], v104 offset:512
    s_waitcnt lgkmcnt(9)
    v_mfma_f32_32x32x16_bf16 v[32:47], v[60:63], v[56:59], v[32:47]
    ds_read_b128 v[56:59], v101 offset:16384
    ds_read_b64_tr_b16 v[60:61], v104 offset:2048
    ds_read_b64_tr_b16 v[62:63], v104 offset:2560
    s_waitcnt lgkmcnt(9)
    v_mfma_f32_32x32x16_bf16 v[32:47], v[68:71], v[64:67], v[32:47]
    ds_read_b128 v[64:67], v102 offset:16384
    ds_read_b64_tr_b16 v[68:69], v104 offset:4096
    ds_read_b64_tr_b16 v[70:71], v104 offset:4608
    s_waitcnt lgkmcnt(9)
    v_mfma_f32_32x32x16_bf16 v[32:47], v[76:79], v[72:75], v[32:47]
    ds_read_b128 v[72:75], v103 offset:16384
    ds_read_b64_tr_b16 v[76:77], v104 offset:6144
    ds_read_b64_tr_b16 v[78:79], v104 offset:6656
    s_waitcnt lgkmcnt(9)
    v_mfma_f32_32x32x16_bf16 v[32:47], v[52:55], v[48:51], v[32:47]
    ds_read_b32 v9, v8 offset:92
    ds_read_b128 v[48:51], v100 offset:24576
    ds_read_b64_tr_b16 v[52:53], v104 offset:8192
    ds_read_b64_tr_b16 v[54:55], v104 offset:8704
    s_waitcnt lgkmcnt(9)
    v_mfma_f32_32x32x16_bf16 v[32:47], v[60:63], v[56:59], v[32:47]
    v_mov_b32 v10, 163280
    v_mov_b32 v11, 1
    s_mov_b64 exec, 1
    ds_add_u32 v10, v11 offset:100
    s_mov_b64 exec, -1
    ds_read_b128 v[56:59], v101 offset:24576
    ds_read_b64_tr_b16 v[60:61], v104 offset:10240
    ds_read_b64_tr_b16 v[62:63], v104 offset:10752
    s_waitcnt lgkmcnt(9)
    v_mfma_f32_32x32x16_bf16 v[32:47], v[68:71], v[64:67], v[32:47]
    ds_read_b128 v[64:67], v102 offset:24576
    ds_read_b64_tr_b16 v[68:69], v104 offset:12288
    ds_read_b64_tr_b16 v[70:71], v104 offset:12800
    s_waitcnt lgkmcnt(9)
    v_mfma_f32_32x32x16_bf16 v[32:47], v[76:79], v[72:75], v[32:47]
    ds_read_b128 v[72:75], v103 offset:24576
    ds_read_b64_tr_b16 v[76:77], v104 offset:14336
    ds_read_b64_tr_b16 v[78:79], v104 offset:14848
    s_waitcnt lgkmcnt(9)
    v_mfma_f32_32x32x16_bf16 v[32:47], v[52:55], v[48:51], v[32:47]
    v_cmp_le_u32 vcc, 12, v9
    s_cbranch_vccnz wqk_11
    v_mov_b32 v8, 163280
    s_mov_b32 s79, 0
lw_12:
    ds_read_b32 v9, v8 offset:92
    s_add_u32 s79, s79, 1
    s_waitcnt lgkmcnt(0)
    v_cmp_le_u32 vcc, 12, v9
    s_cmp_gt_u32 s79, 480000
    s_cbranch_scc1 lg_13
    s_cbranch_vccnz lg_13
    s_branch lw_12
lg_13:
wqk_11:
    ds_read_b128 v[48:51], v100 offset:32768
    ds_read_b64_tr_b16 v[52:53], v104 offset:16384
    ds_read_b64_tr_b16 v[54:55], v104 offset:16896
    s_waitcnt lgkmcnt(9)
    v_mfma_f32_32x32x16_bf16 v[32:47], v[60:63], v[56:59], v[32:47]
    ds_read_b128 v[56:59], v101 offset:32768
    ds_read_b64_tr_b16 v[60:61], v104 offset:18432
    ds_read_b64_tr_b16 v[62:63], v104 offset:18944
    s_waitcnt lgkmcnt(9)
    v_mfma_f32_32x32x16_bf16 v[32:47], v[68:71], v[64:67], v[32:47]
    ds_read_b128 v[64:67], v102 offset:32768
    ds_read_b64_tr_b16 v[68:69], v104 offset:20480
    ds_read_b64_tr_b16 v[70:71], v104 offset:20992
    s_waitcnt lgkmcnt(9)
    v_mfma_f32_32x32x16_bf16 v[32:47], v[76:79], v[72:75], v[32:47]
    ds_read_b128 v[72:75], v103 offset:32768
    ds_read_b64_tr_b16 v[76:77], v104 offset:22528
    ds_read_b64_tr_b16 v[78:79], v104 offset:23040
    s_waitcnt lgkmcnt(9)
    v_mfma_f32_32x32x16_bf16 v[32:47], v[52:55], v[48:51], v[32:47]
    ds_read_b32 v9, v8 offset:92
    ds_read_b128 v[48:51], v100 offset:40960
    ds_read_b64_tr_b16 v[52:53], v104 offset:24576
    ds_read_b64_tr_b16 v[54:55], v104 offset:25088
    s_waitcnt lgkmcnt(9)
    v_mfma_f32_32x32x16_bf16 v[32:47], v[60:63], v[56:59], v[32:47]
    ds_read_b128 v[56:59], v101 offset:40960
    ds_read_b64_tr_b16 v[60:61], v104 offset:26624
    ds_read_b64_tr_b16 v[62:63], v104 offset:27136
    s_waitcnt lgkmcnt(9)
    v_mfma_f32_32x32x16_bf16 v[32:47], v[68:71], v[64:67], v[32:47]
    ds_read_b128 v[64:67], v102 offset:40960
    ds_read_b64_tr_b16 v[68:69], v104 offset:28672
    ds_read_b64_tr_b16 v[70:71], v104 offset:29184
    s_waitcnt lgkmcnt(9)
    v_mfma_f32_32x32x16_bf16 v[32:47], v[76:79], v[72:75], v[32:47]
    ds_read_b128 v[72:75], v103 offset:40960
    ds_read_b64_tr_b16 v[76:77], v104 offset:30720
    ds_read_b64_tr_b16 v[78:79], v104 offset:31232
    s_waitcnt lgkmcnt(9)
    v_mfma_f32_32x32x16_bf16 v[32:47], v[52:55], v[48:51], v[32:47]
    v_cmp_le_u32 vcc, 16, v9
    s_cbranch_vccnz wqk_14
    v_mov_b32 v8, 163280
    s_mov_b32 s79, 0
lw_15:
    ds_read_b32 v9, v8 offset:92
    s_add_u32 s79, s79, 1
    s_waitcnt lgkmcnt(0)
    v_cmp_le_u32 vcc, 16, v9
    s_cmp_gt_u32 s79, 480000
    s_cbranch_scc1 lg_16
    s_cbranch_vccnz lg_16
    s_branch lw_15
lg_16:
wqk_14:
    ds_read_b128 v[48:51], v100 offset:49152
    ds_read_b64_tr_b16 v[52:53], v104 offset:32768
    ds_read_b64_tr_b16 v[54:55], v104 offset:33280
    s_waitcnt lgkmcnt(9)
    v_mfma_f32_32x32x16_bf16 v[32:47], v[60:63], v[56:59], v[32:47]
    ds_read_b128 v[56:59], v101 offset:49152
    ds_read_b64_tr_b16 v[60:61], v104 offset:34816
    ds_read_b64_tr_b16 v[62:63], v104 offset:35328
    s_waitcnt lgkmcnt(9)
    v_mfma_f32_32x32x16_bf16 v[32:47], v[68:71], v[64:67], v[32:47]
    ds_read_b128 v[64:67], v102 offset:49152
    ds_read_b64_tr_b16 v[68:69], v104 offset:36864
    ds_read_b64_tr_b16 v[70:71], v104 offset:37376
    s_waitcnt lgkmcnt(9)
    v_mfma_f32_32x32x16_bf16 v[32:47], v[76:79], v[72:75], v[32:47]
    ds_read_b128 v[72:75], v103 offset:49152
    ds_read_b64_tr_b16 v[76:77], v104 offset:38912
    ds_read_b64_tr_b16 v[78:79], v104 offset:39424
    s_waitcnt lgkmcnt(9)
    v_mfma_f32_32x32x16_bf16 v[32:47], v[52:55], v[48:51], v[32:47]
    ds_read_b128 v[48:51], v100 offset:57344
    ds_read_b64_tr_b16 v[52:53], v104 offset:40960
    ds_read_b64_tr_b16 v[54:55], v104 offset:41472
    s_waitcnt lgkmcnt(9)
    v_mfma_f32_32x32x16_bf16 v[32:47], v[60:63], v[56:59], v[32:47]
    ds_read_b128 v[56:59], v101 offset:57344
    ds_read_b64_tr_b16 v[60:61], v104 offset:43008
    ds_read_b64_tr_b16 v[62:63], v104 offset:43520
    s_waitcnt lgkmcnt(9)
    v_mfma_f32_32x32x16_bf16 v[32:47], v[68:71], v[64:67], v[32:47]
    ds_read_b128 v[64:67], v102 offset:57344
    ds_read_b64_tr_b16 v[68:69], v104 offset:45056
    ds_read_b64_tr_b16 v[70:71], v104 offset:45568
    s_waitcnt lgkmcnt(9)
    v_mfma_f32_32x32x16_bf16 v[32:47], v[76:79], v[72:75], v[32:47]
    s_waitcnt vmcnt(0)
    v_mov_b32 v8, 163280
    v_mov_b32 v9, 1
    s_mov_b64 exec, 1
    ds_add_rtn_u32 v9, v8, v9 offset:8
    ds_read_b64 v[10:11], v8
    v_mov_b32 v12, s74
    s_waitcnt lgkmcnt(0)
    v_cmp_eq_u32 vcc, 7, v9
    s_cbranch_vccz sig_17
    buffer_store_dwordx2 v[10:11], v12, s[4:7], 0 offen sc1
sig_17:
    s_mov_b64 exec, -1
    ds_read_b128 v[72:75], v103 offset:57344
    ds_read_b64_tr_b16 v[76:77], v104 offset:47104
    ds_read_b64_tr_b16 v[78:79], v104 offset:47616
    s_waitcnt lgkmcnt(9)
    v_mfma_f32_32x32x16_bf16 v[32:47], v[52:55], v[48:51], v[32:47]
    s_waitcnt lgkmcnt(6)
    v_mfma_f32_32x32x16_bf16 v[32:47], v[60:63], v[56:59], v[32:47]
    s_waitcnt lgkmcnt(3)
    v_mfma_f32_32x32x16_bf16 v[32:47], v[68:71], v[64:67], v[32:47]
    s_waitcnt lgkmcnt(0)
    v_mfma_f32_32x32x16_bf16 v[32:47], v[76:79], v[72:75], v[32:47]
    v_mov_b32 v8, 163280
    v_mov_b32 v9, 1
    s_mov_b64 exec, 1
    ds_add_u32 v8, v9 offset:96
    s_mov_b64 exec, -1
    s_nop 6
    v_mul_f32 v32, s75, v32
    v_mul_f32 v33, s75, v33
    v_mul_f32 v34, s75, v34
    v_mul_f32 v35, s75, v35
    v_mul_f32 v36, s75, v36
    v_mul_f32 v37, s75, v37
    v_mul_f32 v38, s75, v38
    v_mul_f32 v39, s75, v39
    v_mul_f32 v40, s75, v40
    v_mul_f32 v41, s75, v41
    v_mul_f32 v42, s75, v42
    v_mul_f32 v43, s75, v43
    v_mul_f32 v44, s75, v44
    v_mul_f32 v45, s75, v45
    v_mul_f32 v46, s75, v46
    v_mul_f32 v47, s75, v47
    v_cvt_pk_bf16_f32 v88, v32, v33
    v_cvt_pk_bf16_f32 v89, v34, v35
    v_cvt_pk_bf16_f32 v90, v36, v37
    v_cvt_pk_bf16_f32 v91, v38, v39
    v_cvt_pk_bf16_f32 v92, v40, v41
    v_cvt_pk_bf16_f32 v93, v42, v43
    v_cvt_pk_bf16_f32 v94, v44, v45
    v_cvt_pk_bf16_f32 v95, v46, v47
    buffer_store_dwordx4 v[88:91], v3, s[4:7], s70 offen sc1
    buffer_store_dwordx4 v[92:95], v3, s[4:7], s71 offen sc1
    s_waitcnt vmcnt(0)
    v_mov_b32 v8, 163280
    v_mov_b32 v9, 1
    s_mov_b64 exec, 1
    ds_add_rtn_u32 v9, v8, v9 offset:24
    ds_read_b64 v[10:11], v8
    v_mov_b32 v12, s76
    s_waitcnt lgkmcnt(0)
    v_cmp_eq_u32 vcc, 3, v9
    s_cbranch_vccz sig_18
    buffer_store_dwordx2 v[10:11], v12, s[4:7], 0 offen sc1
sig_18:
    s_mov_b64 exec, -1
    s_branch att_4
g1_3:
    s_mov_b32 s28, s56
    s_mov_b32 s29, s57
    s_mov_b32 s30, 0x100
    s_mov_b32 s31, 0x00020000
    v_and_b32 v7, 15, v2
    v_lshlrev_b32 v7, 4, v7
    v_lshl_add_u32 v7, v5, 8, v7
    v_bfe_u32 v8, v2, 4, 1
    v_lshl_add_u32 v7, v8, 17, v7
    v_mov_b32 v126, 0
    v_mov_b32 v127, 163280
    s_lshl_b32 s75, s62, 5
    s_add_u32 s75, s75, s63
    s_lshl_b32 s75, s75, 3
    s_add_u32 s77, s75, 0xc01000
    s_add_u32 s75, s75, 0xc00800
    s_setprio 3
    s_waitcnt vmcnt(0)
    ds_read_b64_tr_b16 v[80:81], v121 offset:0
    ds_read_b64_tr_b16 v[82:83], v121 offset:512
    ds_read_b64_tr_b16 v[84:85], v121 offset:1024
    ds_read_b64_tr_b16 v[86:87], v121 offset:1536
    ds_read_b64_tr_b16 v[88:89], v121 offset:2048
    ds_read_b64_tr_b16 v[90:91], v121 offset:2560
    ds_read_b64_tr_b16 v[92:93], v121 offset:3072
    ds_read_b64_tr_b16 v[94:95], v121 offset:3584
    ds_read_b64_tr_b16 v[96:97], v121 offset:4096
    v_lshlrev_b32 v48, 16, v124
    v_and_b32 v49, 0xffff0000, v124
    v_lshlrev_b32 v50, 16, v125
    v_and_b32 v51, 0xffff0000, v125
    s_waitcnt lgkmcnt(0)
    v_and_b32 v131, 0xffff0000, v80
    v_lshlrev_b32 v132, 16, v81
    v_and_b32 v133, 0xffff0000, v81
    v_lshlrev_b32 v134, 16, v82
    v_and_b32 v135, 0xffff0000, v82
    v_lshlrev_b32 v136, 16, v83
    v_and_b32 v137, 0xffff0000, v83
    v_lshlrev_b32 v138, 16, v84
    v_and_b32 v139, 0xffff0000, v84
    v_lshlrev_b32 v140, 16, v85
    v_and_b32 v141, 0xffff0000, v85
    v_lshlrev_b32 v142, 16, v86
    v_and_b32 v143, 0xffff0000, v86
    v_lshlrev_b32 v144, 16, v87
    v_and_b32 v145, 0xffff0000, v87
    v_lshlrev_b32 v146, 16, v88
    v_and_b32 v147, 0xffff0000, v88
    v_lshlrev_b32 v148, 16, v89
    v_and_b32 v149, 0xffff0000, v89
    v_lshlrev_b32 v32, 16, v90
    v_and_b32 v33, 0xffff0000, v90
    v_lshlrev_b32 v34, 16, v91
    v_and_b32 v35, 0xffff0000, v91
    v_lshlrev_b32 v36, 16, v92
    v_and_b32 v37, 0xffff0000, v92
    v_lshlrev_b32 v38, 16, v93
    v_and_b32 v39, 0xffff0000, v93
    v_lshlrev_b32 v40, 16, v94
    v_and_b32 v41, 0xffff0000, v94
    v_lshlrev_b32 v42, 16, v95
    v_and_b32 v43, 0xffff0000, v95
    v_lshlrev_b32 v44, 16, v96
    v_and_b32 v45, 0xffff0000, v96
    v_lshlrev_b32 v46, 16, v97
    v_and_b32 v47, 0xffff0000, v97
    v_mul_f32 v110, v51, v131
    v_mul_f32 v111, v51, v132
    v_mul_f32 v112, v51, v133
    v_mul_f32 v113, v51, v134
    v_mul_f32 v114, v51, v135
    v_mul_f32 v115, v51, v136
    v_mul_f32 v116, v51, v137
    v_mul_f32 v117, v51, v138
    v_mul_f32 v118, v51, v139
    v_mul_f32 v150, v51, v140
    v_mul_f32 v151, v51, v141
    v_mul_f32 v152, v51, v142
    v_mul_f32 v153, v51, v143
    v_mul_f32 v154, v51, v144
    v_mul_f32 v155, v51, v145
    v_mul_f32 v156, v51, v146
    v_fmac_f32 v110, v50, v132
    v_fmac_f32 v111, v50, v133
    v_fmac_f32 v112, v50, v134
    v_fmac_f32 v113, v50, v135
    v_fmac_f32 v114, v50, v136
    v_fmac_f32 v115, v50, v137
    v_fmac_f32 v116, v50, v138
    v_fmac_f32 v117, v50, v139
    v_fmac_f32 v118, v50, v140
    v_fmac_f32 v150, v50, v141
    v_fmac_f32 v151, v50, v142
    v_fmac_f32 v152, v50, v143
    v_fmac_f32 v153, v50, v144
    v_fmac_f32 v154, v50, v145
    v_fmac_f32 v155, v50, v146
    v_fmac_f32 v156, v50, v147
    v_fmac_f32 v110, v49, v133
    v_fmac_f32 v111, v49, v134
    v_fmac_f32 v112, v49, v135
    v_fmac_f32 v113, v49, v136
    v_fmac_f32 v114, v49, v137
    v_fmac_f32 v115, v49, v138
    v_fmac_f32 v116, v49, v139
    v_fmac_f32 v117, v49, v140
    v_fmac_f32 v118, v49, v141
    v_fmac_f32 v150, v49, v142
    v_fmac_f32 v151, v49, v143
    v_fmac_f32 v152, v49, v144
    v_fmac_f32 v153, v49, v145
    v_fmac_f32 v154, v49, v146
    v_fmac_f32 v155, v49, v147
    v_fmac_f32 v156, v49, v148
    v_fmac_f32 v110, v48, v134
    v_fmac_f32 v111, v48, v135
    v_fmac_f32 v112, v48, v136
    v_fmac_f32 v113, v48, v137
    v_fmac_f32 v114, v48, v138
    v_fmac_f32 v115, v48, v139
    v_fmac_f32 v116, v48, v140
    v_fmac_f32 v117, v48, v141
    v_fmac_f32 v118, v48, v142
    v_fmac_f32 v150, v48, v143
    v_fmac_f32 v151, v48, v144
    v_fmac_f32 v152, v48, v145
    v_fmac_f32 v153, v48, v146
    v_fmac_f32 v154, v48, v147
    v_fmac_f32 v155, v48, v148
    v_fmac_f32 v156, v48, v149
    v_mul_f32 v110, v110, v32
    v_mul_f32 v111, v111, v33
    v_mul_f32 v112, v112, v34
    v_mul_f32 v113, v113, v35
    v_mul_f32 v114, v114, v36
    v_mul_f32 v115, v115, v37
    v_mul_f32 v116, v116, v38
    v_mul_f32 v117, v117, v39
    v_mul_f32 v118, v118, v40
    v_mul_f32 v150, v150, v41
    v_mul_f32 v151, v151, v42
    v_mul_f32 v152, v152, v43
    v_mul_f32 v153, v153, v44
    v_mul_f32 v154, v154, v45
    v_mul_f32 v155, v155, v46
    v_mul_f32 v156, v156, v47
    v_cvt_pk_bf16_f32 v80, v156, v155
    v_cvt_pk_bf16_f32 v81, v154, v153
    v_cvt_pk_bf16_f32 v82, v152, v151
    v_cvt_pk_bf16_f32 v83, v150, v118
    v_cvt_pk_bf16_f32 v84, v117, v116
    v_cvt_pk_bf16_f32 v85, v115, v114
    v_cvt_pk_bf16_f32 v86, v113, v112
    v_cvt_pk_bf16_f32 v87, v111, v110
    buffer_store_dwordx4 v[80:83], v122, s[4:7], 0 offen sc1
    buffer_store_dwordx4 v[84:87], v123, s[4:7], 0 offen sc1
    s_setprio 0
    s_lshl_b32 s70, s62, 8
    s_add_u32 s70, s70, 0xc00800
    v_lshlrev_b32 v98, 3, v4
    s_barrier
    ds_read_b128 v[48:51], v100 offset:0
    ds_read_b64_tr_b16 v[52:53], v104 offset:8192
    ds_read_b64_tr_b16 v[54:55], v104 offset:8704
    ds_read_b128 v[56:59], v101 offset:0
    ds_read_b64_tr_b16 v[60:61], v104 offset:10240
    ds_read_b64_tr_b16 v[62:63], v104 offset:10752
    ds_read_b128 v[64:67], v102 offset:0
    ds_read_b64_tr_b16 v[68:69], v104 offset:12288
    ds_read_b64_tr_b16 v[70:71], v104 offset:12800
    ds_read_b128 v[72:75], v103 offset:0
    ds_read_b64_tr_b16 v[76:77], v104 offset:14336
    ds_read_b64_tr_b16 v[78:79], v104 offset:14848
    s_waitcnt lgkmcnt(9)
    v_mfma_f32_32x32x16_bf16 v[16:31], v[48:51], v[52:55], v[16:31]
    s_cmp_lg_u32 s3, 7
    s_cbranch_scc1 nl_20
    buffer_load_dwordx2 v[128:129], v126, s[28:31], 0 offen sc1
nl_20:
    s_waitcnt lgkmcnt(0)
    s_barrier
    ds_read_b128 v[48:51], v100 offset:8192
    ds_read_b64_tr_b16 v[52:53], v104 offset:24576
    ds_read_b64_tr_b16 v[54:55], v104 offset:25088
    s_waitcnt lgkmcnt(9)
    v_mfma_f32_32x32x16_bf16 v[16:31], v[56:59], v[60:63], v[16:31]
    ds_read_b128 v[56:59], v101 offset:8192
    ds_read_b64_tr_b16 v[60:61], v104 offset:26624
    ds_read_b64_tr_b16 v[62:63], v104 offset:27136
    s_waitcnt lgkmcnt(9)
    v_mfma_f32_32x32x16_bf16 v[16:31], v[64:67], v[68:71], v[16:31]
    ds_read_b128 v[64:67], v102 offset:8192
    ds_read_b64_tr_b16 v[68:69], v104 offset:28672
    ds_read_b64_tr_b16 v[70:71], v104 offset:29184
    s_waitcnt lgkmcnt(9)
    v_mfma_f32_32x32x16_bf16 v[16:31], v[72:75], v[76:79], v[16:31]
    ds_read_b128 v[72:75], v103 offset:8192
    ds_read_b64_tr_b16 v[76:77], v104 offset:30720
    ds_read_b64_tr_b16 v[78:79], v104 offset:31232
    s_waitcnt lgkmcnt(9)
    v_mfma_f32_32x32x16_bf16 v[16:31], v[48:51], v[52:55], v[16:31]
    s_waitcnt lgkmcnt(0)
    s_barrier
    ds_read_b128 v[48:51], v100 offset:16384
    ds_read_b64_tr_b16 v[52:53], v104 offset:40960
    ds_read_b64_tr_b16 v[54:55], v104 offset:41472
    s_waitcnt lgkmcnt(9)
    v_mfma_f32_32x32x16_bf16 v[16:31], v[56:59], v[60:63], v[16:31]
    ds_read_b128 v[56:59], v101 offset:16384
    ds_read_b64_tr_b16 v[60:61], v104 offset:43008
    ds_read_b64_tr_b16 v[62:63], v104 offset:43520
    s_waitcnt lgkmcnt(9)
    v_mfma_f32_32x32x16_bf16 v[16:31], v[64:67], v[68:71], v[16:31]
    ds_read_b128 v[64:67], v102 offset:16384
    ds_read_b64_tr_b16 v[68:69], v104 offset:45056
    ds_read_b64_tr_b16 v[70:71], v104 offset:45568
    s_waitcnt lgkmcnt(9)
    v_mfma_f32_32x32x16_bf16 v[16:31], v[72:75], v[76:79], v[16:31]
    s_cmp_lg_u32 s3, 7
    s_cbranch_scc1 nqd_23
    s_mov_b32 s78, 0
    s_branch nqc_22
nq_21:
    buffer_load_dwordx2 v[128:129], v126, s[28:31], 0 offen sc1
    s_add_u32 s78, s78, 1
nqc_22:
    s_waitcnt vmcnt(0)
    v_cmp_ne_u32 vcc, 0, v128
    s_cmp_gt_u32 s78, 30000
    s_cbranch_scc1 nqd_23
    s_cbranch_vccz nq_21
    ds_write_b64 v127, v[128:129]
nqd_23:
    s_waitcnt vmcnt(0)
    v_mov_b32 v8, 163280
    v_mov_b32 v9, 1
    s_mov_b64 exec, 1
    ds_add_rtn_u32 v9, v8, v9 offset:12
    ds_read_b64 v[10:11], v8
    v_mov_b32 v12, s75
    s_waitcnt lgkmcnt(0)
    v_cmp_eq_u32 vcc, 3, v9
    s_cbranch_vccz sig_24
    buffer_store_dwordx2 v[10:11], v12, s[4:7], 0 offen sc1
sig_24:
    s_mov_b64 exec, -1
    ds_read_b128 v[72:75], v103 offset:16384
    ds_read_b64_tr_b16 v[76:77], v104 offset:47104
    ds_read_b64_tr_b16 v[78:79], v104 offset:47616
    s_waitcnt lgkmcnt(9)
    v_mfma_f32_32x32x16_bf16 v[16:31], v[48:51], v[52:55], v[16:31]
    s_waitcnt lgkmcnt(0)
    s_barrier
    ds_read_b128 v[48:51], v100 offset:24576
    ds_read_b64_tr_b16 v[52:53], v104 offset:57344
    ds_read_b64_tr_b16 v[54:55], v104 offset:57856
    s_waitcnt lgkmcnt(9)
    v_mfma_f32_32x32x16_bf16 v[16:31], v[56:59], v[60:63], v[16:31]
    ds_read_b128 v[56:59], v101 offset:24576
    ds_read_b64_tr_b16 v[60:61], v104 offset:59392
    ds_read_b64_tr_b16 v[62:63], v104 offset:59904
    s_waitcnt lgkmcnt(9)
    v_mfma_f32_32x32x16_bf16 v[16:31], v[64:67], v[68:71], v[16:31]
    ds_read_b128 v[64:67], v102 offset:24576
    ds_read_b64_tr_b16 v[68:69], v104 offset:61440
    ds_read_b64_tr_b16 v[70:71], v104 offset:61952
    s_waitcnt lgkmcnt(9)
    v_mfma_f32_32x32x16_bf16 v[16:31], v[72:75], v[76:79], v[16:31]
    ds_read_b128 v[72:75], v103 offset:24576
    ds_read_b64_tr_b16 v[76:77], v104 offset:63488
    ds_read_b64_tr_b16 v[78:79], v104 offset:64000
    s_waitcnt lgkmcnt(9)
    v_mfma_f32_32x32x16_bf16 v[16:31], v[48:51], v[52:55], v[16:31]
    s_waitcnt lgkmcnt(0)
    s_barrier
    ds_read_b128 v[48:51], v100 offset:32768
    ds_read_b64_tr_b16 v[52:53], v104 offset:8192
    ds_read_b64_tr_b16 v[54:55], v104 offset:8704
    s_waitcnt lgkmcnt(9)
    v_mfma_f32_32x32x16_bf16 v[16:31], v[56:59], v[60:63], v[16:31]
    ds_read_b128 v[56:59], v101 offset:32768
    ds_read_b64_tr_b16 v[60:61], v104 offset:10240
    ds_read_b64_tr_b16 v[62:63], v104 offset:10752
    s_waitcnt lgkmcnt(9)
    v_mfma_f32_32x32x16_bf16 v[16:31], v[64:67], v[68:71], v[16:31]
    ds_read_b128 v[64:67], v102 offset:32768
    ds_read_b64_tr_b16 v[68:69], v104 offset:12288
    ds_read_b64_tr_b16 v[70:71], v104 offset:12800
    s_waitcnt lgkmcnt(9)
    v_mfma_f32_32x32x16_bf16 v[16:31], v[72:75], v[76:79], v[16:31]
    ds_read_b128 v[72:75], v103 offset:32768
    ds_read_b64_tr_b16 v[76:77], v104 offset:14336
    ds_read_b64_tr_b16 v[78:79], v104 offset:14848
    s_waitcnt lgkmcnt(9)
    v_mfma_f32_32x32x16_bf16 v[16:31], v[48:51], v[52:55], v[16:31]
    s_waitcnt lgkmcnt(0)
    s_barrier
    ds_read_b128 v[48:51], v100 offset:40960
    ds_read_b64_tr_b16 v[52:53], v104 offset:24576
    ds_read_b64_tr_b16 v[54:55], v104 offset:25088
    s_waitcnt lgkmcnt(9)
    v_mfma_f32_32x32x16_bf16 v[16:31], v[56:59], v[60:63], v[16:31]
    s_cmp_lg_u32 s3, 7
    s_cbranch_scc1 f2i_25
    buffer_load_dwordx2 v[96:97], v98, s[4:7], s70 offen sc1
f2i_25:
    ds_read_b128 v[56:59], v101 offset:40960
    ds_read_b64_tr_b16 v[60:61], v104 offset:26624
    ds_read_b64_tr_b16 v[62:63], v104 offset:27136
    s_waitcnt lgkmcnt(9)
    v_mfma_f32_32x32x16_bf16 v[16:31], v[64:67], v[68:71], v[16:31]
    ds_read_b128 v[64:67], v102 offset:40960
    ds_read_b64_tr_b16 v[68:69], v104 offset:28672
    ds_read_b64_tr_b16 v[70:71], v104 offset:29184
    s_waitcnt lgkmcnt(9)
    v_mfma_f32_32x32x16_bf16 v[16:31], v[72:75], v[76:79], v[16:31]
    ds_read_b128 v[72:75], v103 offset:40960
    ds_read_b64_tr_b16 v[76:77], v104 offset:30720
    ds_read_b64_tr_b16 v[78:79], v104 offset:31232
    s_waitcnt lgkmcnt(9)
    v_mfma_f32_32x32x16_bf16 v[16:31], v[48:51], v[52:55], v[16:31]
    s_waitcnt lgkmcnt(0)
    s_barrier
    ds_read_b128 v[48:51], v100 offset:49152
    ds_read_b64_tr_b16 v[52:53], v104 offset:40960
    ds_read_b64_tr_b16 v[54:55], v104 offset:41472
    s_waitcnt lgkmcnt(9)
    v_mfma_f32_32x32x16_bf16 v[16:31], v[56:59], v[60:63], v[16:31]
    ds_read_b128 v[56:59], v101 offset:49152
    ds_read_b64_tr_b16 v[60:61], v104 offset:43008
    ds_read_b64_tr_b16 v[62:63], v104 offset:43520
    s_waitcnt lgkmcnt(9)
    v_mfma_f32_32x32x16_bf16 v[16:31], v[64:67], v[68:71], v[16:31]
    ds_read_b128 v[64:67], v102 offset:49152
    ds_read_b64_tr_b16 v[68:69], v104 offset:45056
    ds_read_b64_tr_b16 v[70:71], v104 offset:45568
    s_waitcnt lgkmcnt(9)
    v_mfma_f32_32x32x16_bf16 v[16:31], v[72:75], v[76:79], v[16:31]
    ds_read_b128 v[72:75], v103 offset:49152
    ds_read_b64_tr_b16 v[76:77], v104 offset:47104
    ds_read_b64_tr_b16 v[78:79], v104 offset:47616
    s_waitcnt lgkmcnt(9)
    v_mfma_f32_32x32x16_bf16 v[16:31], v[48:51], v[52:55], v[16:31]
    s_waitcnt lgkmcnt(0)
    s_barrier
    ds_read_b128 v[48:51], v100 offset:57344
    ds_read_b64_tr_b16 v[52:53], v104 offset:57344
    ds_read_b64_tr_b16 v[54:55], v104 offset:57856
    s_waitcnt lgkmcnt(9)
    v_mfma_f32_32x32x16_bf16 v[16:31], v[56:59], v[60:63], v[16:31]
    s_cmp_lg_u32 s3, 7
    s_cbranch_scc1 fqd_29
    s_mov_b32 s78, 0
    s_branch fqc_27
fq_26:
    buffer_load_dwordx2 v[96:97], v98, s[4:7], s70 offen sc1
    s_add_u32 s78, s78, 1
fqc_27:
    s_waitcnt vmcnt(0)
    v_cmp_eq_u64 vcc, v[128:129], v[96:97]
    s_cmp_gt_u32 s78, 30000
    s_cbranch_scc1 fok_28
    s_cmp_eq_u64 vcc, exec
    s_cbranch_scc0 fq_26
fok_28:
    v_mov_b32 v8, 163280
    v_mov_b32 v9, 1
    s_mov_b64 exec, 1
    ds_add_u32 v8, v9 offset:48
    s_mov_b64 exec, -1
fqd_29:
    ds_read_b128 v[56:59], v101 offset:57344
    ds_read_b64_tr_b16 v[60:61], v104 offset:59392
    ds_read_b64_tr_b16 v[62:63], v104 offset:59904
    s_waitcnt lgkmcnt(9)
    v_mfma_f32_32x32x16_bf16 v[16:31], v[64:67], v[68:71], v[16:31]
    ds_read_b128 v[64:67], v102 offset:57344
    ds_read_b64_tr_b16 v[68:69], v104 offset:61440
    ds_read_b64_tr_b16 v[70:71], v104 offset:61952
    s_waitcnt lgkmcnt(9)
    v_mfma_f32_32x32x16_bf16 v[16:31], v[72:75], v[76:79], v[16:31]
    ds_read_b128 v[72:75], v103 offset:57344
    ds_read_b64_tr_b16 v[76:77], v104 offset:63488
    ds_read_b64_tr_b16 v[78:79], v104 offset:64000
    s_waitcnt lgkmcnt(9)
    v_mfma_f32_32x32x16_bf16 v[16:31], v[48:51], v[52:55], v[16:31]
    s_waitcnt lgkmcnt(6)
    v_mfma_f32_32x32x16_bf16 v[16:31], v[56:59], v[60:63], v[16:31]
    s_waitcnt lgkmcnt(3)
    v_mfma_f32_32x32x16_bf16 v[16:31], v[64:67], v[68:71], v[16:31]
    s_waitcnt lgkmcnt(0)
    v_mfma_f32_32x32x16_bf16 v[16:31], v[72:75], v[76:79], v[16:31]
    s_nop 11
    v_cvt_pk_bf16_f32 v144, v16, v17
    v_cvt_pk_bf16_f32 v145, v18, v19
    v_cvt_pk_bf16_f32 v146, v20, v21
    v_cvt_pk_bf16_f32 v147, v22, v23
    v_cvt_pk_bf16_f32 v148, v24, v25
    v_cvt_pk_bf16_f32 v149, v26, v27
    v_cvt_pk_bf16_f32 v150, v28, v29
    v_cvt_pk_bf16_f32 v151, v30, v31
    buffer_store_dwordx4 v[144:147], v7, s[4:7], s72 offen offset:1024 sc1
    buffer_store_dwordx4 v[148:151], v7, s[4:7], s72 offen offset:1536 sc1
    s_bfe_u32 s72, s3, 0x10001
    s_and_b32 s73, s3, 1
    s_mul_i32 s75, s72, 8528
    s_add_u32 s75, s75, 132096
    v_and_b32 v8, 1, v2
    v_add_u32 v9, v4, v8
    v_lshlrev_b32 v9, 1, v9
    v_lshl_add_u32 v9, v5, 4, v9
    v_xor_b32 v8, 1, v8
    v_mul_u32_u24 v8, 4292, v8
    v_add_u32 v9, v9, v8
    v_add_u32 v16, s75, v9
    s_lshl_b32 s76, s73, 10
    s_add_u32 s76, s76, 64
    v_add_u32 v17, s76, v16
    v_add_u32 v18, 0x800, v17
    v_sub_u32 v19, 31, v4
    v_mul_u32_u24 v19, 144, v19
    v_lshl_add_u32 v19, v5, 5, v19
    s_lshl_b32 s76, s72, 4
    s_add_u32 s76, s76, 149152
    v_add_u32 v19, s76, v19
    s_xor_b32 s78, s73, 1
    s_mul_i32 s76, s78, 4608
    v_add_u32 v20, s76, v19
    s_mul_i32 s76, s73, 2304
    v_add_u32 v19, s76, v19
    s_and_b32 s76, s3, 3
    s_lshl_b32 s76, s76, 13
    s_add_u32 s76, s76, 82560
    v_add_u32 v21, s76, v3
    v_mov_b32 v32, 0
    v_mov_b32 v33, 0
    v_mov_b32 v34, 0
    v_mov_b32 v35, 0
    v_mov_b32 v36, 0
    v_mov_b32 v37, 0
    v_mov_b32 v38, 0
    v_mov_b32 v39, 0
    v_mov_b32 v40, 0
    v_mov_b32 v41, 0
    v_mov_b32 v42, 0
    v_mov_b32 v43, 0
    v_mov_b32 v44, 0
    v_mov_b32 v45, 0
    v_mov_b32 v46, 0
    v_mov_b32 v47, 0
    v_mov_b32 v48, 0
    v_mov_b32 v49, 0
    v_mov_b32 v50, 0
    v_mov_b32 v51, 0
    v_mov_b32 v52, 0
    v_mov_b32 v53, 0
    v_mov_b32 v54, 0
    v_mov_b32 v55, 0
    v_mov_b32 v56, 0
    v_mov_b32 v57, 0
    v_mov_b32 v58, 0
    v_mov_b32 v59, 0
    v_mov_b32 v60, 0
    v_mov_b32 v61, 0
    v_mov_b32 v62, 0
    v_mov_b32 v63, 0
    s_lshl_b32 s68, s67, 3
    s_add_u32 s68, s68, s3
    v_and_b32 v8, 15, v2
    v_lshlrev_b32 v8, 4, v8
    v_lshrrev_b32 v9, 5, v2
    v_lshl_add_u32 v8, v9, 8, v8
    v_add_u32 v140, 0x400, v8
    v_add_u32 v10, 0x600, v8
    v_mov_b32 v11, 0x40000
    v_and_b32 v12, 16, v2
    v_cmp_eq_u32 vcc, 0, v12
    v_mov_b32 v7, 0xdddddddd
    v_mov_b32 v4, v3
    v_cndmask_b32 v5, v11, v140, vcc
    v_cndmask_b32 v6, v11, v10, vcc
    s_mov_b32 exec_lo, 0x10010000
    s_mov_b32 exec_hi, 0x10010000
    v_mov_b32 v5, 0x800
    v_mov_b32 v6, 0x800
    s_mov_b64 exec, -1
    s_lshl_b32 s34, s68, 15
    s_lshl_b32 s35, s66, 10
    s_add_u32 s34, s34, s35
    s_add_u32 s34, s34, 0x800000
    s_lshl_b32 s35, s67, 5
    s_add_u32 s35, s35, s66
    s_lshl_b32 s35, s35, 3
    s_add_u32 s35, s35, 0xc01800
    s_lshl_b32 s70, s66, 16
    s_lshl_b32 s71, s68, 10
    s_add_u32 s70, s70, s71
    s_mov_b32 s71, 0
    v_mov_b32 v14, 163280
    v_mov_b32 v15, 1
    v_mov_b32 v136, 0
    v_mov_b32 v137, 0
    v_mov_b32 v138, 0
    v_mov_b32 v139, 0
    s_waitcnt vmcnt(0)
    v_mov_b32 v8, 163280
    v_mov_b32 v9, 1
    s_mov_b64 exec, 1
    ds_add_rtn_u32 v9, v8, v9 offset:8
    ds_read_b64 v[10:11], v8
    v_mov_b32 v12, s74
    s_waitcnt lgkmcnt(0)
    v_cmp_eq_u32 vcc, 7, v9
    s_cbranch_vccz sig_30
    buffer_store_dwordx2 v[10:11], v12, s[4:7], 0 offen sc1
sig_30:
    s_mov_b64 exec, -1
    v_mov_b32 v8, 163280
    s_mov_b32 s79, 0
lw_31:
    ds_read_b32 v9, v8 offset:40
    s_add_u32 s79, s79, 1
    s_waitcnt lgkmcnt(0)
    v_cmp_le_u32 vcc, 4, v9
    s_cmp_gt_u32 s79, 480000
    s_cbranch_scc1 lg_32
    s_cbranch_vccnz lg_32
    s_sleep 1
    s_branch lw_31
lg_32:
    s_setprio 2
    ds_read2_b32 v[96:97], v16 offset0:0 offset1:1
    ds_read2_b32 v[98:99], v16 offset0:2 offset1:3
    ds_read_b128 v[104:107], v20
    ds_read2_b32 v[100:101], v16 offset0:8 offset1:9
    ds_read2_b32 v[102:103], v16 offset0:10 offset1:11
    ds_read_b128 v[108:111], v20 offset:64
    ds_read2_b32 v[64:65], v17 offset0:0 offset1:1
    ds_read2_b32 v[66:67], v17 offset0:2 offset1:3
    ds_read_b128 v[72:75], v19 offset:4608
    ds_read_b128 v[76:79], v19 offset:0
    ds_read2_b32 v[68:69], v18 offset0:0 offset1:1
    ds_read2_b32 v[70:71], v18 offset0:2 offset1:3
    s_waitcnt lgkmcnt(6)
    s_cmp_eq_u32 s73, 1
    s_cbranch_scc1 dg1_33
    v_mfma_f32_32x32x16_bf16 v[32:47], v[96:99], v[104:107], v[32:47]
    v_mfma_f32_32x32x16_bf16 v[32:47], v[100:103], v[108:111], v[32:47]
    s_branch dg2_34
dg1_33:
    v_mfma_f32_32x32x16_bf16 v[48:63], v[96:99], v[104:107], v[48:63]
    v_mfma_f32_32x32x16_bf16 v[48:63], v[100:103], v[108:111], v[48:63]
dg2_34:
    ds_read2_b32 v[80:81], v17 offset0:8 offset1:9
    ds_read2_b32 v[82:83], v17 offset0:10 offset1:11
    ds_read_b128 v[88:91], v19 offset:4672
    ds_read_b128 v[92:95], v19 offset:64
    ds_read2_b32 v[84:85], v18 offset0:8 offset1:9
    ds_read2_b32 v[86:87], v18 offset0:10 offset1:11
    s_waitcnt lgkmcnt(6)
    v_mfma_f32_32x32x16_bf16 v[32:47], v[64:67], v[72:75], v[32:47]
    ds_read2_b32 v[96:97], v17 offset0:16 offset1:17
    ds_read2_b32 v[98:99], v17 offset0:18 offset1:19
    v_mfma_f32_32x32x16_bf16 v[48:63], v[64:67], v[76:79], v[48:63]
    ds_read_b128 v[104:107], v19 offset:4752
    ds_read_b128 v[108:111], v19 offset:144
    v_mfma_f32_32x32x16_bf16 v[48:63], v[68:71], v[72:75], v[48:63]
    ds_read2_b32 v[100:101], v18 offset0:16 offset1:17
    ds_read2_b32 v[102:103], v18 offset0:18 offset1:19
    s_waitcnt lgkmcnt(6)
    v_mfma_f32_32x32x16_bf16 v[32:47], v[80:83], v[88:91], v[32:47]
    ds_read2_b32 v[64:65], v17 offset0:24 offset1:25
    ds_read2_b32 v[66:67], v17 offset0:26 offset1:27
    v_mfma_f32_32x32x16_bf16 v[48:63], v[80:83], v[92:95], v[48:63]
    ds_read_b128 v[72:75], v19 offset:4816
    ds_read_b128 v[76:79], v19 offset:208
    v_mfma_f32_32x32x16_bf16 v[48:63], v[84:87], v[88:91], v[48:63]
    ds_read2_b32 v[68:69], v18 offset0:24 offset1:25
    ds_read2_b32 v[70:71], v18 offset0:26 offset1:27
    s_waitcnt lgkmcnt(6)
    v_mfma_f32_32x32x16_bf16 v[32:47], v[96:99], v[104:107], v[32:47]
    ds_read2_b32 v[80:81], v17 offset0:32 offset1:33
    ds_read2_b32 v[82:83], v17 offset0:34 offset1:35
    v_mfma_f32_32x32x16_bf16 v[48:63], v[96:99], v[108:111], v[48:63]
    ds_read_b128 v[88:91], v19 offset:4896
    ds_read_b128 v[92:95], v19 offset:288
    v_mfma_f32_32x32x16_bf16 v[48:63], v[100:103], v[104:107], v[48:63]
    ds_read2_b32 v[84:85], v18 offset0:32 offset1:33
    ds_read2_b32 v[86:87], v18 offset0:34 offset1:35
    s_waitcnt lgkmcnt(6)
    v_mfma_f32_32x32x16_bf16 v[32:47], v[64:67], v[72:75], v[32:47]
    ds_read2_b32 v[96:97], v17 offset0:40 offset1:41
    ds_read2_b32 v[98:99], v17 offset0:42 offset1:43
    v_mfma_f32_32x32x16_bf16 v[48:63], v[64:67], v[76:79], v[48:63]
    ds_read_b128 v[104:107], v19 offset:4960
    ds_read_b128 v[108:111], v19 offset:352
    v_mfma_f32_32x32x16_bf16 v[48:63], v[68:71], v[72:75], v[48:63]
    ds_read2_b32 v[100:101], v18 offset0:40 offset1:41
    ds_read2_b32 v[102:103], v18 offset0:42 offset1:43
    s_waitcnt lgkmcnt(6)
    v_mfma_f32_32x32x16_bf16 v[32:47], v[80:83], v[88:91], v[32:47]
    ds_read2_b32 v[64:65], v17 offset0:48 offset1:49
    ds_read2_b32 v[66:67], v17 offset0:50 offset1:51
    v_mfma_f32_32x32x16_bf16 v[48:63], v[80:83], v[92:95], v[48:63]
    ds_read_b128 v[72:75], v19 offset:5040
    ds_read_b128 v[76:79], v19 offset:432
    v_mfma_f32_32x32x16_bf16 v[48:63], v[84:87], v[88:91], v[48:63]
    ds_read2_b32 v[68:69], v18 offset0:48 offset1:49
    ds_read2_b32 v[70:71], v18 offset0:50 offset1:51
    s_waitcnt lgkmcnt(6)
    v_mfma_f32_32x32x16_bf16 v[32:47], v[96:99], v[104:107], v[32:47]
    ds_read2_b32 v[80:81], v17 offset0:56 offset1:57
    ds_read2_b32 v[82:83], v17 offset0:58 offset1:59
    v_mfma_f32_32x32x16_bf16 v[48:63], v[96:99], v[108:111], v[48:63]
    ds_read_b128 v[88:91], v19 offset:5104
    ds_read_b128 v[92:95], v19 offset:496
    v_mfma_f32_32x32x16_bf16 v[48:63], v[100:103], v[104:107], v[48:63]
    ds_read2_b32 v[84:85], v18 offset0:56 offset1:57
    ds_read2_b32 v[86:87], v18 offset0:58 offset1:59
    s_waitcnt lgkmcnt(6)
    v_mfma_f32_32x32x16_bf16 v[32:47], v[64:67], v[72:75], v[32:47]
    ds_read2_b32 v[96:97], v17 offset0:64 offset1:65
    ds_read2_b32 v[98:99], v17 offset0:66 offset1:67
    v_mfma_f32_32x32x16_bf16 v[48:63], v[64:67], v[76:79], v[48:63]
    ds_read_b128 v[104:107], v19 offset:5184
    ds_read_b128 v[108:111], v19 offset:576
    v_mfma_f32_32x32x16_bf16 v[48:63], v[68:71], v[72:75], v[48:63]
    ds_read2_b32 v[100:101], v18 offset0:64 offset1:65
    ds_read2_b32 v[102:103], v18 offset0:66 offset1:67
    s_waitcnt lgkmcnt(6)
    v_mfma_f32_32x32x16_bf16 v[32:47], v[80:83], v[88:91], v[32:47]
    ds_read2_b32 v[64:65], v17 offset0:72 offset1:73
    ds_read2_b32 v[66:67], v17 offset0:74 offset1:75
    v_mfma_f32_32x32x16_bf16 v[48:63], v[80:83], v[92:95], v[48:63]
    ds_read_b128 v[72:75], v19 offset:5248
    ds_read_b128 v[76:79], v19 offset:640
    v_mfma_f32_32x32x16_bf16 v[48:63], v[84:87], v[88:91], v[48:63]
    ds_read2_b32 v[68:69], v18 offset0:72 offset1:73
    ds_read2_b32 v[70:71], v18 offset0:74 offset1:75
    s_waitcnt lgkmcnt(6)
    v_mfma_f32_32x32x16_bf16 v[32:47], v[96:99], v[104:107], v[32:47]
    ds_read2_b32 v[80:81], v17 offset0:80 offset1:81
    ds_read2_b32 v[82:83], v17 offset0:82 offset1:83
    v_mfma_f32_32x32x16_bf16 v[48:63], v[96:99], v[108:111], v[48:63]
    ds_read_b128 v[88:91], v19 offset:5328
    ds_read_b128 v[92:95], v19 offset:720
    v_mfma_f32_32x32x16_bf16 v[48:63], v[100:103], v[104:107], v[48:63]
    ds_read2_b32 v[84:85], v18 offset0:80 offset1:81
    ds_read2_b32 v[86:87], v18 offset0:82 offset1:83
    s_waitcnt lgkmcnt(6)
    v_mfma_f32_32x32x16_bf16 v[32:47], v[64:67], v[72:75], v[32:47]
    ds_read2_b32 v[96:97], v17 offset0:88 offset1:89
    ds_read2_b32 v[98:99], v17 offset0:90 offset1:91
    v_mfma_f32_32x32x16_bf16 v[48:63], v[64:67], v[76:79], v[48:63]
    ds_read_b128 v[104:107], v19 offset:5392
    ds_read_b128 v[108:111], v19 offset:784
    v_mfma_f32_32x32x16_bf16 v[48:63], v[68:71], v[72:75], v[48:63]
    ds_read2_b32 v[100:101], v18 offset0:88 offset1:89
    ds_read2_b32 v[102:103], v18 offset0:90 offset1:91
    s_waitcnt lgkmcnt(6)
    ds_read_b32 v9, v8 offset:52
    v_mfma_f32_32x32x16_bf16 v[32:47], v[80:83], v[88:91], v[32:47]
    ds_read2_b32 v[64:65], v17 offset0:96 offset1:97
    ds_read2_b32 v[66:67], v17 offset0:98 offset1:99
    v_mfma_f32_32x32x16_bf16 v[48:63], v[80:83], v[92:95], v[48:63]
    ds_read_b128 v[72:75], v19 offset:5472
    ds_read_b128 v[76:79], v19 offset:864
    v_mfma_f32_32x32x16_bf16 v[48:63], v[84:87], v[88:91], v[48:63]
    ds_read2_b32 v[68:69], v18 offset0:96 offset1:97
    ds_read2_b32 v[70:71], v18 offset0:98 offset1:99
    s_waitcnt lgkmcnt(6)
    v_mfma_f32_32x32x16_bf16 v[32:47], v[96:99], v[104:107], v[32:47]
    ds_read2_b32 v[80:81], v17 offset0:104 offset1:105
    ds_read2_b32 v[82:83], v17 offset0:106 offset1:107
    v_mfma_f32_32x32x16_bf16 v[48:63], v[96:99], v[108:111], v[48:63]
    ds_read_b128 v[88:91], v19 offset:5536
    ds_read_b128 v[92:95], v19 offset:928
    v_mfma_f32_32x32x16_bf16 v[48:63], v[100:103], v[104:107], v[48:63]
    ds_read2_b32 v[84:85], v18 offset0:104 offset1:105
    ds_read2_b32 v[86:87], v18 offset0:106 offset1:107
    s_waitcnt lgkmcnt(6)
    v_cmp_le_u32 vcc, 1, v9
    s_cmp_lg_u32 s71, 0
    s_cbranch_scc1 qe_35
    s_cbranch_vccz qe_35
    buffer_load_dwordx4 v[112:115], v3, s[4:7], s70 offen sc1
    s_mov_b32 s71, 1
qe_35:
    v_mfma_f32_32x32x16_bf16 v[32:47], v[64:67], v[72:75], v[32:47]
    ds_read2_b32 v[96:97], v17 offset0:112 offset1:113
    ds_read2_b32 v[98:99], v17 offset0:114 offset1:115
    v_mfma_f32_32x32x16_bf16 v[48:63], v[64:67], v[76:79], v[48:63]
    ds_read_b128 v[104:107], v19 offset:5616
    ds_read_b128 v[108:111], v19 offset:1008
    v_mfma_f32_32x32x16_bf16 v[48:63], v[68:71], v[72:75], v[48:63]
    ds_read2_b32 v[100:101], v18 offset0:112 offset1:113
    ds_read2_b32 v[102:103], v18 offset0:114 offset1:115
    s_waitcnt lgkmcnt(6)
    ds_read_b32 v9, v8 offset:52
    v_mfma_f32_32x32x16_bf16 v[32:47], v[80:83], v[88:91], v[32:47]
    ds_read2_b32 v[64:65], v17 offset0:120 offset1:121
    ds_read2_b32 v[66:67], v17 offset0:122 offset1:123
    v_mfma_f32_32x32x16_bf16 v[48:63], v[80:83], v[92:95], v[48:63]
    ds_read_b128 v[72:75], v19 offset:5680
    ds_read_b128 v[76:79], v19 offset:1072
    v_mfma_f32_32x32x16_bf16 v[48:63], v[84:87], v[88:91], v[48:63]
    ds_read2_b32 v[68:69], v18 offset0:120 offset1:121
    ds_read2_b32 v[70:71], v18 offset0:122 offset1:123
    s_waitcnt lgkmcnt(6)
    v_mfma_f32_32x32x16_bf16 v[32:47], v[96:99], v[104:107], v[32:47]
    ds_read2_b32 v[80:81], v17 offset0:128 offset1:129
    ds_read2_b32 v[82:83], v17 offset0:130 offset1:131
    v_mfma_f32_32x32x16_bf16 v[48:63], v[96:99], v[108:111], v[48:63]
    ds_read_b128 v[88:91], v19 offset:5760
    ds_read_b128 v[92:95], v19 offset:1152
    v_mfma_f32_32x32x16_bf16 v[48:63], v[100:103], v[104:107], v[48:63]
    ds_read2_b32 v[84:85], v18 offset0:128 offset1:129
    ds_read2_b32 v[86:87], v18 offset0:130 offset1:131
    s_waitcnt lgkmcnt(6)
    v_cmp_le_u32 vcc, 1, v9
    s_cmp_lg_u32 s71, 0
    s_cbranch_scc1 qe_36
    s_cbranch_vccz qe_36
    buffer_load_dwordx4 v[112:115], v3, s[4:7], s70 offen sc1
    s_mov_b32 s71, 1
qe_36:
    v_mfma_f32_32x32x16_bf16 v[32:47], v[64:67], v[72:75], v[32:47]
    ds_read2_b32 v[96:97], v17 offset0:136 offset1:137
    ds_read2_b32 v[98:99], v17 offset0:138 offset1:139
    v_mfma_f32_32x32x16_bf16 v[48:63], v[64:67], v[76:79], v[48:63]
    ds_read_b128 v[104:107], v19 offset:5824
    ds_read_b128 v[108:111], v19 offset:1216
    v_mfma_f32_32x32x16_bf16 v[48:63], v[68:71], v[72:75], v[48:63]
    ds_read2_b32 v[100:101], v18 offset0:136 offset1:137
    ds_read2_b32 v[102:103], v18 offset0:138 offset1:139
    s_waitcnt lgkmcnt(6)
    ds_read_b32 v9, v8 offset:52
    v_mfma_f32_32x32x16_bf16 v[32:47], v[80:83], v[88:91], v[32:47]
    ds_read2_b32 v[64:65], v17 offset0:144 offset1:145
    ds_read2_b32 v[66:67], v17 offset0:146 offset1:147
    v_mfma_f32_32x32x16_bf16 v[48:63], v[80:83], v[92:95], v[48:63]
    ds_read_b128 v[72:75], v19 offset:5904
    ds_read_b128 v[76:79], v19 offset:1296
    v_mfma_f32_32x32x16_bf16 v[48:63], v[84:87], v[88:91], v[48:63]
    ds_read2_b32 v[68:69], v18 offset0:144 offset1:145
    ds_read2_b32 v[70:71], v18 offset0:146 offset1:147
    s_waitcnt lgkmcnt(6)
    v_mfma_f32_32x32x16_bf16 v[32:47], v[96:99], v[104:107], v[32:47]
    ds_read2_b32 v[80:81], v17 offset0:152 offset1:153
    ds_read2_b32 v[82:83], v17 offset0:154 offset1:155
    v_mfma_f32_32x32x16_bf16 v[48:63], v[96:99], v[108:111], v[48:63]
    ds_read_b128 v[88:91], v19 offset:5968
    ds_read_b128 v[92:95], v19 offset:1360
    v_mfma_f32_32x32x16_bf16 v[48:63], v[100:103], v[104:107], v[48:63]
    ds_read2_b32 v[84:85], v18 offset0:152 offset1:153
    ds_read2_b32 v[86:87], v18 offset0:154 offset1:155
    s_waitcnt lgkmcnt(6)
    v_cmp_le_u32 vcc, 1, v9
    s_cmp_lg_u32 s71, 0
    s_cbranch_scc1 qe_37
    s_cbranch_vccz qe_37
    buffer_load_dwordx4 v[112:115], v3, s[4:7], s70 offen sc1
    s_mov_b32 s71, 1
qe_37:
    v_mfma_f32_32x32x16_bf16 v[32:47], v[64:67], v[72:75], v[32:47]
    ds_read2_b32 v[96:97], v17 offset0:160 offset1:161
    ds_read2_b32 v[98:99], v17 offset0:162 offset1:163
    v_mfma_f32_32x32x16_bf16 v[48:63], v[64:67], v[76:79], v[48:63]
    ds_read_b128 v[104:107], v19 offset:6048
    ds_read_b128 v[108:111], v19 offset:1440
    v_mfma_f32_32x32x16_bf16 v[48:63], v[68:71], v[72:75], v[48:63]
    ds_read2_b32 v[100:101], v18 offset0:160 offset1:161
    ds_read2_b32 v[102:103], v18 offset0:162 offset1:163
    s_waitcnt lgkmcnt(6)
    v_mfma_f32_32x32x16_bf16 v[32:47], v[80:83], v[88:91], v[32:47]
    ds_read2_b32 v[64:65], v17 offset0:168 offset1:169
    ds_read2_b32 v[66:67], v17 offset0:170 offset1:171
    v_mfma_f32_32x32x16_bf16 v[48:63], v[80:83], v[92:95], v[48:63]
    ds_read_b128 v[72:75], v19 offset:6112
    ds_read_b128 v[76:79], v19 offset:1504
    v_mfma_f32_32x32x16_bf16 v[48:63], v[84:87], v[88:91], v[48:63]
    ds_read2_b32 v[68:69], v18 offset0:168 offset1:169
    ds_read2_b32 v[70:71], v18 offset0:170 offset1:171
    s_waitcnt lgkmcnt(6)
    ds_read_b32 v9, v8 offset:52
    v_mfma_f32_32x32x16_bf16 v[32:47], v[96:99], v[104:107], v[32:47]
    ds_read2_b32 v[80:81], v17 offset0:176 offset1:177
    ds_read2_b32 v[82:83], v17 offset0:178 offset1:179
    v_mfma_f32_32x32x16_bf16 v[48:63], v[96:99], v[108:111], v[48:63]
    ds_read_b128 v[88:91], v19 offset:6192
    ds_read_b128 v[92:95], v19 offset:1584
    v_mfma_f32_32x32x16_bf16 v[48:63], v[100:103], v[104:107], v[48:63]
    ds_read2_b32 v[84:85], v18 offset0:176 offset1:177
    ds_read2_b32 v[86:87], v18 offset0:178 offset1:179
    s_waitcnt lgkmcnt(6)
    v_mfma_f32_32x32x16_bf16 v[32:47], v[64:67], v[72:75], v[32:47]
    ds_read2_b32 v[96:97], v17 offset0:184 offset1:185
    ds_read2_b32 v[98:99], v17 offset0:186 offset1:187
    v_mfma_f32_32x32x16_bf16 v[48:63], v[64:67], v[76:79], v[48:63]
    ds_read_b128 v[104:107], v19 offset:6256
    ds_read_b128 v[108:111], v19 offset:1648
    v_mfma_f32_32x32x16_bf16 v[48:63], v[68:71], v[72:75], v[48:63]
    ds_read2_b32 v[100:101], v18 offset0:184 offset1:185
    ds_read2_b32 v[102:103], v18 offset0:186 offset1:187
    s_waitcnt lgkmcnt(6)
    v_cmp_le_u32 vcc, 1, v9
    s_cmp_lg_u32 s71, 0
    s_cbranch_scc1 qe_38
    s_cbranch_vccz qe_38
    buffer_load_dwordx4 v[112:115], v3, s[4:7], s70 offen sc1
    s_mov_b32 s71, 1
qe_38:
    v_mfma_f32_32x32x16_bf16 v[32:47], v[80:83], v[88:91], v[32:47]
    ds_read2_b32 v[64:65], v17 offset0:192 offset1:193
    ds_read2_b32 v[66:67], v17 offset0:194 offset1:195
    v_mfma_f32_32x32x16_bf16 v[48:63], v[80:83], v[92:95], v[48:63]
    ds_read_b128 v[72:75], v19 offset:6336
    ds_read_b128 v[76:79], v19 offset:1728
    v_mfma_f32_32x32x16_bf16 v[48:63], v[84:87], v[88:91], v[48:63]
    ds_read2_b32 v[68:69], v18 offset0:192 offset1:193
    ds_read2_b32 v[70:71], v18 offset0:194 offset1:195
    s_waitcnt lgkmcnt(6)
    v_mfma_f32_32x32x16_bf16 v[32:47], v[96:99], v[104:107], v[32:47]
    ds_read2_b32 v[80:81], v17 offset0:200 offset1:201
    ds_read2_b32 v[82:83], v17 offset0:202 offset1:203
    v_mfma_f32_32x32x16_bf16 v[48:63], v[96:99], v[108:111], v[48:63]
    ds_read_b128 v[88:91], v19 offset:6400
    ds_read_b128 v[92:95], v19 offset:1792
    v_mfma_f32_32x32x16_bf16 v[48:63], v[100:103], v[104:107], v[48:63]
    ds_read2_b32 v[84:85], v18 offset0:200 offset1:201
    ds_read2_b32 v[86:87], v18 offset0:202 offset1:203
    s_waitcnt lgkmcnt(6)
    ds_read_b32 v9, v8 offset:52
    v_mfma_f32_32x32x16_bf16 v[32:47], v[64:67], v[72:75], v[32:47]
    ds_read2_b32 v[96:97], v17 offset0:208 offset1:209
    ds_read2_b32 v[98:99], v17 offset0:210 offset1:211
    v_mfma_f32_32x32x16_bf16 v[48:63], v[64:67], v[76:79], v[48:63]
    ds_read_b128 v[104:107], v19 offset:6480
    ds_read_b128 v[108:111], v19 offset:1872
    v_mfma_f32_32x32x16_bf16 v[48:63], v[68:71], v[72:75], v[48:63]
    ds_read2_b32 v[100:101], v18 offset0:208 offset1:209
    ds_read2_b32 v[102:103], v18 offset0:210 offset1:211
    s_waitcnt lgkmcnt(6)
    v_mfma_f32_32x32x16_bf16 v[32:47], v[80:83], v[88:91], v[32:47]
    ds_read2_b32 v[64:65], v17 offset0:216 offset1:217
    ds_read2_b32 v[66:67], v17 offset0:218 offset1:219
    v_mfma_f32_32x32x16_bf16 v[48:63], v[80:83], v[92:95], v[48:63]
    ds_read_b128 v[72:75], v19 offset:6544
    ds_read_b128 v[76:79], v19 offset:1936
    v_mfma_f32_32x32x16_bf16 v[48:63], v[84:87], v[88:91], v[48:63]
    ds_read2_b32 v[68:69], v18 offset0:216 offset1:217
    ds_read2_b32 v[70:71], v18 offset0:218 offset1:219
    s_waitcnt lgkmcnt(6)
    v_cmp_le_u32 vcc, 1, v9
    s_cmp_lg_u32 s71, 0
    s_cbranch_scc1 qe_39
    s_cbranch_vccz qe_39
    buffer_load_dwordx4 v[112:115], v3, s[4:7], s70 offen sc1
    s_mov_b32 s71, 1
qe_39:
    v_mfma_f32_32x32x16_bf16 v[32:47], v[96:99], v[104:107], v[32:47]
    ds_read2_b32 v[80:81], v17 offset0:224 offset1:225
    ds_read2_b32 v[82:83], v17 offset0:226 offset1:227
    v_mfma_f32_32x32x16_bf16 v[48:63], v[96:99], v[108:111], v[48:63]
    ds_read_b128 v[88:91], v19 offset:6624
    ds_read_b128 v[92:95], v19 offset:2016
    v_mfma_f32_32x32x16_bf16 v[48:63], v[100:103], v[104:107], v[48:63]
    ds_read2_b32 v[84:85], v18 offset0:224 offset1:225
    ds_read2_b32 v[86:87], v18 offset0:226 offset1:227
    s_waitcnt lgkmcnt(6)
    ds_read_b32 v9, v8 offset:52
    v_mfma_f32_32x32x16_bf16 v[32:47], v[64:67], v[72:75], v[32:47]
    ds_read2_b32 v[96:97], v17 offset0:232 offset1:233
    ds_read2_b32 v[98:99], v17 offset0:234 offset1:235
    v_mfma_f32_32x32x16_bf16 v[48:63], v[64:67], v[76:79], v[48:63]
    ds_read_b128 v[104:107], v19 offset:6688
    ds_read_b128 v[108:111], v19 offset:2080
    v_mfma_f32_32x32x16_bf16 v[48:63], v[68:71], v[72:75], v[48:63]
    ds_read2_b32 v[100:101], v18 offset0:232 offset1:233
    ds_read2_b32 v[102:103], v18 offset0:234 offset1:235
    s_waitcnt lgkmcnt(6)
    v_mfma_f32_32x32x16_bf16 v[32:47], v[80:83], v[88:91], v[32:47]
    ds_read2_b32 v[64:65], v17 offset0:240 offset1:241
    ds_read2_b32 v[66:67], v17 offset0:242 offset1:243
    v_mfma_f32_32x32x16_bf16 v[48:63], v[80:83], v[92:95], v[48:63]
    ds_read_b128 v[72:75], v19 offset:6768
    ds_read_b128 v[76:79], v19 offset:2160
    v_mfma_f32_32x32x16_bf16 v[48:63], v[84:87], v[88:91], v[48:63]
    ds_read2_b32 v[68:69], v18 offset0:240 offset1:241
    ds_read2_b32 v[70:71], v18 offset0:242 offset1:243
    s_waitcnt lgkmcnt(6)
    v_cmp_le_u32 vcc, 1, v9
    s_cmp_lg_u32 s71, 0
    s_cbranch_scc1 qe_40
    s_cbranch_vccz qe_40
    buffer_load_dwordx4 v[112:115], v3, s[4:7], s70 offen sc1
    s_mov_b32 s71, 1
qe_40:
    v_mfma_f32_32x32x16_bf16 v[32:47], v[96:99], v[104:107], v[32:47]
    ds_read2_b32 v[80:81], v17 offset0:248 offset1:249
    ds_read2_b32 v[82:83], v17 offset0:250 offset1:251
    v_mfma_f32_32x32x16_bf16 v[48:63], v[96:99], v[108:111], v[48:63]
    ds_read_b128 v[88:91], v19 offset:6832
    ds_read_b128 v[92:95], v19 offset:2224
    v_mfma_f32_32x32x16_bf16 v[48:63], v[100:103], v[104:107], v[48:63]
    ds_read2_b32 v[84:85], v18 offset0:248 offset1:249
    ds_read2_b32 v[86:87], v18 offset0:250 offset1:251
    s_waitcnt lgkmcnt(6)
    v_mfma_f32_32x32x16_bf16 v[32:47], v[64:67], v[72:75], v[32:47]
    v_mfma_f32_32x32x16_bf16 v[48:63], v[64:67], v[76:79], v[48:63]
    v_mfma_f32_32x32x16_bf16 v[48:63], v[68:71], v[72:75], v[48:63]
    s_waitcnt lgkmcnt(0)
    v_mfma_f32_32x32x16_bf16 v[32:47], v[80:83], v[88:91], v[32:47]
    v_mfma_f32_32x32x16_bf16 v[48:63], v[80:83], v[92:95], v[48:63]
    v_mfma_f32_32x32x16_bf16 v[48:63], v[84:87], v[88:91], v[48:63]
    s_setprio 3
    s_cmp_lg_u32 s71, 0
    s_cbranch_scc1 qd2_41
    v_mov_b32 v8, 163280
    s_mov_b32 s79, 0
lw_42:
    ds_read_b32 v9, v8 offset:52
    s_add_u32 s79, s79, 1
    s_waitcnt lgkmcnt(0)
    v_cmp_le_u32 vcc, 1, v9
    s_cmp_gt_u32 s79, 480000
    s_cbranch_scc1 lg_43
    s_cbranch_vccnz lg_43
    s_sleep 1
    s_branch lw_42
lg_43:
    buffer_load_dwordx4 v[112:115], v3, s[4:7], s70 offen sc1
qd2_41:
    v_mov_b32 v8, 163280
    s_mov_b32 s79, 0
lw_44:
    ds_read_b32 v9, v8 offset:28
    s_add_u32 s79, s79, 1
    s_waitcnt lgkmcnt(0)
    v_cmp_le_u32 vcc, 4, v9
    s_cmp_gt_u32 s79, 480000
    s_cbranch_scc1 lg_45
    s_cbranch_vccnz lg_45
    s_sleep 1
    s_branch lw_44
lg_45:
    ds_read_b128 v[116:119], v4
    ds_read_b128 v[120:123], v4 offset:2064
    ds_read_b128 v[124:127], v5
    ds_write_b128 v21, v[32:35] offset:0
    ds_write_b128 v21, v[36:39] offset:1024
    ds_write_b128 v21, v[40:43] offset:2048
    ds_write_b128 v21, v[44:47] offset:3072
    ds_write_b128 v21, v[48:51] offset:4096
    ds_write_b128 v21, v[52:55] offset:5120
    ds_write_b128 v21, v[56:59] offset:6144
    ds_write_b128 v21, v[60:63] offset:7168
    s_mov_b64 exec, 1
    ds_add_u32 v14, v15 offset:104
    s_mov_b64 exec, -1
    s_waitcnt vmcnt(0) lgkmcnt(11)
    v_mfma_f32_32x32x16_bf16 v[16:31], v[116:119], v[112:115], 0
    s_setprio 1
    v_mov_b32 v80, 0
    v_mov_b32 v81, 0
    v_mov_b32 v82, 0
    v_mov_b32 v83, 0
    v_mov_b32 v84, 0
    v_mov_b32 v85, 0
    v_mov_b32 v86, 0
    v_mov_b32 v87, 0
    v_mov_b32 v88, 0
    v_mov_b32 v89, 0
    v_mov_b32 v90, 0
    v_mov_b32 v91, 0
    v_mov_b32 v92, 0
    v_mov_b32 v93, 0
    v_mov_b32 v94, 0
    v_mov_b32 v95, 0
    v_mov_b32 v72, 0
    v_mov_b32 v73, 0
    v_mov_b32 v74, 0
    v_mov_b32 v75, 0
    v_mov_b32 v76, 0
    v_mov_b32 v77, 0
    v_mov_b32 v78, 0
    v_mov_b32 v79, 0
    s_branch amax_5
att_4:
    s_lshl_b32 s68, s67, 3
    s_add_u32 s68, s68, s3
    v_and_b32 v8, 15, v2
    v_lshlrev_b32 v8, 4, v8
    v_lshrrev_b32 v9, 5, v2
    v_lshl_add_u32 v8, v9, 8, v8
    v_add_u32 v140, 0x400, v8
    v_add_u32 v10, 0x600, v8
    v_mov_b32 v11, 0x40000
    v_and_b32 v12, 16, v2
    v_cmp_eq_u32 vcc, 0, v12
    v_mov_b32 v7, 0xdddddddd
    v_mov_b32 v4, v3
    v_cndmask_b32 v5, v11, v140, vcc
    v_cndmask_b32 v6, v11, v10, vcc
    s_mov_b32 exec_lo, 0x10010000
    s_mov_b32 exec_hi, 0x10010000
    v_mov_b32 v5, 0x800
    v_mov_b32 v6, 0x800
    s_mov_b64 exec, -1
    s_lshl_b32 s34, s68, 15
    s_lshl_b32 s35, s66, 10
    s_add_u32 s34, s34, s35
    s_add_u32 s34, s34, 0x800000
    s_lshl_b32 s35, s67, 5
    s_add_u32 s35, s35, s66
    s_lshl_b32 s35, s35, 3
    s_add_u32 s35, s35, 0xc01800
    s_lshl_b32 s70, s66, 16
    s_lshl_b32 s71, s68, 10
    s_add_u32 s70, s70, s71
    s_mov_b32 s71, 0
    v_mov_b32 v14, 163280
    v_mov_b32 v15, 1
    v_mov_b32 v136, 0
    v_mov_b32 v137, 0
    v_mov_b32 v138, 0
    v_mov_b32 v139, 0
    v_mov_b32 v80, 0
    v_mov_b32 v81, 0
    v_mov_b32 v82, 0
    v_mov_b32 v83, 0
    v_mov_b32 v84, 0
    v_mov_b32 v85, 0
    v_mov_b32 v86, 0
    v_mov_b32 v87, 0
    v_mov_b32 v88, 0
    v_mov_b32 v89, 0
    v_mov_b32 v90, 0
    v_mov_b32 v91, 0
    v_mov_b32 v92, 0
    v_mov_b32 v93, 0
    v_mov_b32 v94, 0
    v_mov_b32 v95, 0
    v_mov_b32 v72, 0
    v_mov_b32 v73, 0
    v_mov_b32 v74, 0
    v_mov_b32 v75, 0
    v_mov_b32 v76, 0
    v_mov_b32 v77, 0
    v_mov_b32 v78, 0
    v_mov_b32 v79, 0
    s_cmp_lg_u32 s3, 0
    s_cbranch_scc1 qpo_46
    ds_read_b64 v[10:11], v14
    s_lshr_b32 s78, s66, 2
    s_lshl_b32 s78, s78, 8
    s_lshl_b32 s79, s67, 5
    s_add_u32 s78, s78, s79
    s_add_u32 s78, s78, 0xc02000
    s_waitcnt lgkmcnt(0)
    v_readfirstlane_b32 s60, v10
    v_readfirstlane_b32 s61, v11
    v_mov_b32 v8, 163280
    s_mov_b32 s71, 0
lw_48:
    ds_read_b32 v9, v8 offset:24
    s_add_u32 s71, s71, 1
    s_waitcnt lgkmcnt(0)
    v_cmp_le_u32 vcc, 4, v9
    s_cmp_gt_u32 s71, 480000
    s_cbranch_scc1 lg_49
    s_cbranch_vccnz lg_49
    s_sleep 1
    s_branch lw_48
lg_49:
    v_mov_b32 v8, 163280
    s_mov_b32 s71, 0
lw_50:
    ds_read_b32 v9, v8 offset:8
    s_add_u32 s71, s71, 1
    s_waitcnt lgkmcnt(0)
    v_cmp_le_u32 vcc, 8, v9
    s_cmp_gt_u32 s71, 480000
    s_cbranch_scc1 lg_51
    s_cbranch_vccnz lg_51
    s_sleep 1
    s_branch lw_50
lg_51:
    v_and_b32 v10, 3, v2
    v_lshlrev_b32 v10, 3, v10
    s_mov_b32 s79, 0
poll_52:
    buffer_load_dwordx2 v[8:9], v10, s[4:7], s78 offen sc1
    s_add_u32 s79, s79, 1
    s_waitcnt vmcnt(0)
    v_cmp_eq_u64 vcc, s[60:61], v[8:9]
    s_cmp_gt_u32 s79, 30000
    s_cbranch_scc1 pgo_53
    s_cmp_eq_u64 vcc, exec
    s_cbranch_scc1 pgo_53
    s_sleep 1
    s_branch poll_52
pgo_53:
    v_mov_b32 v8, 163280
    v_mov_b32 v9, 1
    s_mov_b64 exec, 1
    ds_add_u32 v8, v9 offset:52
    s_mov_b64 exec, -1
    s_branch qpd_47
qpo_46:
    v_mov_b32 v8, 163280
    s_mov_b32 s71, 0
lw_54:
    ds_read_b32 v9, v8 offset:52
    s_add_u32 s71, s71, 1
    s_waitcnt lgkmcnt(0)
    v_cmp_le_u32 vcc, 1, v9
    s_cmp_gt_u32 s71, 480000
    s_cbranch_scc1 lg_55
    s_cbranch_vccnz lg_55
    s_sleep 1
    s_branch lw_54
lg_55:
qpd_47:
    buffer_load_dwordx4 v[112:115], v3, s[4:7], s70 offen sc1
    v_mov_b32 v8, 163280
    s_mov_b32 s71, 0
lw_56:
    ds_read_b32 v9, v8 offset:28
    s_add_u32 s71, s71, 1
    s_waitcnt lgkmcnt(0)
    v_cmp_le_u32 vcc, 4, v9
    s_cmp_gt_u32 s71, 480000
    s_cbranch_scc1 lg_57
    s_cbranch_vccnz lg_57
    s_sleep 1
    s_branch lw_56
lg_57:
    ds_read_b128 v[116:119], v4
    ds_read_b128 v[120:123], v4 offset:2064
    ds_read_b128 v[124:127], v5
    s_waitcnt vmcnt(0) lgkmcnt(2)
    v_mfma_f32_32x32x16_bf16 v[16:31], v[116:119], v[112:115], 0
    s_setprio 0
    s_nop 10
amax_5:
    v_max3_f32 v8, v16, v17, v18
    v_max3_f32 v9, v19, v20, v21
    v_max3_f32 v8, v8, v22, v23
    v_max3_f32 v9, v9, v24, v25
    v_max3_f32 v8, v8, v26, v27
    v_max3_f32 v9, v9, v28, v29
    v_max3_f32 v8, v8, v30, v31
    v_max_f32 v8, v8, v9
    v_max_f32 v9, v8, v9
    s_nop 1
    v_permlane32_swap_b32 v8, v9
    s_nop 1
    v_max_f32 v8, v8, v9
    v_sub_f32 v96, 0, v8
    v_sub_f32 v97, 0, v8
    v_sub_f32 v98, 0, v8
    v_sub_f32 v99, 0, v8
    v_sub_f32 v100, 0, v8
    v_sub_f32 v101, 0, v8
    v_sub_f32 v102, 0, v8
    v_sub_f32 v103, 0, v8
    v_sub_f32 v104, 0, v8
    v_sub_f32 v105, 0, v8
    v_sub_f32 v106, 0, v8
    v_sub_f32 v107, 0, v8
    v_sub_f32 v108, 0, v8
    v_sub_f32 v109, 0, v8
    v_sub_f32 v110, 0, v8
    v_sub_f32 v111, 0, v8
    s_waitcnt lgkmcnt(0)
    s_mov_b32 s69, 0
    v_mfma_f32_32x32x16_bf16 v[16:31], v[116:119], v[112:115], v[96:111]
    v_mfma_f32_32x32x16_bf16 v[32:47], v[120:123], v[112:115], v[96:111]
    s_nop 3
    ds_read_b128 v[116:119], v4 offset:4128
    s_nop 7
loop_58:
    ds_read_b128 v[132:135], v6 offset:0
    v_exp_f32 v16, v16
    v_exp_f32 v17, v17
    v_exp_f32 v18, v18
    v_exp_f32 v19, v19
    v_exp_f32 v20, v20
    s_waitcnt lgkmcnt(1)
    v_smfmac_f32_32x32x32_bf16 v[80:95], v[136:139], v[72:79], v7
    ds_read_b128 v[128:131], v5 offset:2064
    v_exp_f32 v21, v21
    v_exp_f32 v22, v22
    v_exp_f32 v23, v23
    v_exp_f32 v24, v24
    v_exp_f32 v25, v25
    v_smfmac_f32_32x32x32_bf16 v[80:95], v[124:127], v[16:23], v7
    ds_read_b128 v[120:123], v4 offset:6192
    v_exp_f32 v26, v26
    v_exp_f32 v27, v27
    v_exp_f32 v28, v28
    v_exp_f32 v29, v29
    v_exp_f32 v30, v30
    v_exp_f32 v31, v31
    v_mfma_f32_32x32x16_bf16 v[48:63], v[116:119], v[112:115], v[96:111]
    ds_read_b128 v[136:139], v6 offset:2064
    v_exp_f32 v32, v32
    v_exp_f32 v33, v33
    v_exp_f32 v34, v34
    v_exp_f32 v35, v35
    v_exp_f32 v36, v36
    s_waitcnt lgkmcnt(1)
    v_smfmac_f32_32x32x32_bf16 v[80:95], v[132:135], v[24:31], v7
    ds_read_b128 v[124:127], v5 offset:4128
    v_exp_f32 v37, v37
    v_exp_f32 v38, v38
    v_exp_f32 v39, v39
    v_exp_f32 v40, v40
    v_exp_f32 v41, v41
    v_smfmac_f32_32x32x32_bf16 v[80:95], v[128:131], v[32:39], v7
    ds_read_b128 v[116:119], v4 offset:8256
    v_exp_f32 v42, v42
    v_exp_f32 v43, v43
    v_exp_f32 v44, v44
    v_exp_f32 v45, v45
    v_exp_f32 v46, v46
    v_exp_f32 v47, v47
    v_mfma_f32_32x32x16_bf16 v[64:79], v[120:123], v[112:115], v[96:111]
    s_cmp_eq_u32 s69, 3
    s_cbranch_scc1 oo_59
ob_60:
    ds_read_b128 v[132:135], v6 offset:4128
    v_exp_f32 v48, v48
    v_exp_f32 v49, v49
    v_exp_f32 v50, v50
    v_exp_f32 v51, v51
    v_exp_f32 v52, v52
    s_waitcnt lgkmcnt(1)
    v_smfmac_f32_32x32x32_bf16 v[80:95], v[136:139], v[40:47], v7
    ds_read_b128 v[128:131], v5 offset:6192
    v_exp_f32 v53, v53
    v_exp_f32 v54, v54
    v_exp_f32 v55, v55
    v_exp_f32 v56, v56
    v_exp_f32 v57, v57
    v_smfmac_f32_32x32x32_bf16 v[80:95], v[124:127], v[48:55], v7
    ds_read_b128 v[120:123], v4 offset:10320
    v_exp_f32 v58, v58
    v_exp_f32 v59, v59
    v_exp_f32 v60, v60
    v_exp_f32 v61, v61
    v_exp_f32 v62, v62
    v_exp_f32 v63, v63
    v_mfma_f32_32x32x16_bf16 v[16:31], v[116:119], v[112:115], v[96:111]
    s_cmp_eq_u32 s69, 2
    s_cbranch_scc1 oo_61
ob_62:
    ds_read_b128 v[136:139], v6 offset:6192
    v_exp_f32 v64, v64
    v_exp_f32 v65, v65
    v_exp_f32 v66, v66
    v_exp_f32 v67, v67
    v_exp_f32 v68, v68
    s_waitcnt lgkmcnt(1)
    v_smfmac_f32_32x32x32_bf16 v[80:95], v[132:135], v[56:63], v7
    ds_read_b128 v[124:127], v5 offset:8256
    v_exp_f32 v69, v69
    v_exp_f32 v70, v70
    v_exp_f32 v71, v71
    v_exp_f32 v72, v72
    v_exp_f32 v73, v73
    v_smfmac_f32_32x32x32_bf16 v[80:95], v[128:131], v[64:71], v7
    ds_read_b128 v[116:119], v4 offset:12384
    v_exp_f32 v74, v74
    v_exp_f32 v75, v75
    v_exp_f32 v76, v76
    v_exp_f32 v77, v77
    v_exp_f32 v78, v78
    v_exp_f32 v79, v79
    v_mfma_f32_32x32x16_bf16 v[32:47], v[120:123], v[112:115], v[96:111]
    s_cmp_eq_u32 s69, 0
    s_cbranch_scc1 oo_63
ob_64:
    ds_read_b128 v[132:135], v6 offset:8256
    v_exp_f32 v16, v16
    v_exp_f32 v17, v17
    v_exp_f32 v18, v18
    v_exp_f32 v19, v19
    v_exp_f32 v20, v20
    s_waitcnt lgkmcnt(1)
    v_smfmac_f32_32x32x32_bf16 v[80:95], v[136:139], v[72:79], v7
    ds_read_b128 v[128:131], v5 offset:10320
    v_exp_f32 v21, v21
    v_exp_f32 v22, v22
    v_exp_f32 v23, v23
    v_exp_f32 v24, v24
    v_exp_f32 v25, v25
    v_smfmac_f32_32x32x32_bf16 v[80:95], v[124:127], v[16:23], v7
    ds_read_b128 v[120:123], v4 offset:14448
    v_exp_f32 v26, v26
    v_exp_f32 v27, v27
    v_exp_f32 v28, v28
    v_exp_f32 v29, v29
    v_exp_f32 v30, v30
    v_exp_f32 v31, v31
    v_mfma_f32_32x32x16_bf16 v[48:63], v[116:119], v[112:115], v[96:111]
    ds_read_b128 v[136:139], v6 offset:10320
    v_exp_f32 v32, v32
    v_exp_f32 v33, v33
    v_exp_f32 v34, v34
    v_exp_f32 v35, v35
    v_exp_f32 v36, v36
    s_waitcnt lgkmcnt(1)
    v_smfmac_f32_32x32x32_bf16 v[80:95], v[132:135], v[24:31], v7
    ds_read_b128 v[124:127], v5 offset:12384
    v_exp_f32 v37, v37
    v_exp_f32 v38, v38
    v_exp_f32 v39, v39
    v_exp_f32 v40, v40
    v_exp_f32 v41, v41
    v_smfmac_f32_32x32x32_bf16 v[80:95], v[128:131], v[32:39], v7
    ds_read_b128 v[116:119], v4 offset:16512
    v_exp_f32 v42, v42
    v_exp_f32 v43, v43
    v_exp_f32 v44, v44
    v_exp_f32 v45, v45
    v_exp_f32 v46, v46
    v_exp_f32 v47, v47
    v_mfma_f32_32x32x16_bf16 v[64:79], v[120:123], v[112:115], v[96:111]
    ds_read_b128 v[132:135], v6 offset:12384
    v_exp_f32 v48, v48
    v_exp_f32 v49, v49
    v_exp_f32 v50, v50
    v_exp_f32 v51, v51
    v_exp_f32 v52, v52
    s_waitcnt lgkmcnt(1)
    v_smfmac_f32_32x32x32_bf16 v[80:95], v[136:139], v[40:47], v7
    ds_read_b128 v[128:131], v5 offset:14448
    v_exp_f32 v53, v53
    v_exp_f32 v54, v54
    v_exp_f32 v55, v55
    v_exp_f32 v56, v56
    v_exp_f32 v57, v57
    v_smfmac_f32_32x32x32_bf16 v[80:95], v[124:127], v[48:55], v7
    ds_read_b128 v[120:123], v4 offset:18576
    v_exp_f32 v58, v58
    v_exp_f32 v59, v59
    v_exp_f32 v60, v60
    v_exp_f32 v61, v61
    v_exp_f32 v62, v62
    v_exp_f32 v63, v63
    v_mfma_f32_32x32x16_bf16 v[16:31], v[116:119], v[112:115], v[96:111]
    ds_read_b128 v[136:139], v6 offset:14448
    v_exp_f32 v64, v64
    v_exp_f32 v65, v65
    v_exp_f32 v66, v66
    v_exp_f32 v67, v67
    v_exp_f32 v68, v68
    s_waitcnt lgkmcnt(1)
    v_smfmac_f32_32x32x32_bf16 v[80:95], v[132:135], v[56:63], v7
    ds_read_b128 v[124:127], v5 offset:16512
    v_exp_f32 v69, v69
    v_exp_f32 v70, v70
    v_exp_f32 v71, v71
    v_exp_f32 v72, v72
    v_exp_f32 v73, v73
    v_smfmac_f32_32x32x32_bf16 v[80:95], v[128:131], v[64:71], v7
    ds_read_b128 v[116:119], v4 offset:20640
    v_exp_f32 v74, v74
    v_exp_f32 v75, v75
    v_exp_f32 v76, v76
    v_exp_f32 v77, v77
    v_exp_f32 v78, v78
    v_exp_f32 v79, v79
    v_mfma_f32_32x32x16_bf16 v[32:47], v[120:123], v[112:115], v[96:111]
    ds_read_b128 v[132:135], v6 offset:16512
    v_exp_f32 v16, v16
    v_exp_f32 v17, v17
    v_exp_f32 v18, v18
    v_exp_f32 v19, v19
    v_exp_f32 v20, v20
    s_waitcnt lgkmcnt(1)
    v_smfmac_f32_32x32x32_bf16 v[80:95], v[136:139], v[72:79], v7
    ds_read_b128 v[128:131], v5 offset:18576
    v_exp_f32 v21, v21
    v_exp_f32 v22, v22
    v_exp_f32 v23, v23
    v_exp_f32 v24, v24
    v_exp_f32 v25, v25
    v_smfmac_f32_32x32x32_bf16 v[80:95], v[124:127], v[16:23], v7
    ds_read_b128 v[120:123], v4 offset:22704
    v_exp_f32 v26, v26
    v_exp_f32 v27, v27
    v_exp_f32 v28, v28
    v_exp_f32 v29, v29
    v_exp_f32 v30, v30
    v_exp_f32 v31, v31
    v_mfma_f32_32x32x16_bf16 v[48:63], v[116:119], v[112:115], v[96:111]
    ds_read_b128 v[136:139], v6 offset:18576
    v_exp_f32 v32, v32
    v_exp_f32 v33, v33
    v_exp_f32 v34, v34
    v_exp_f32 v35, v35
    v_exp_f32 v36, v36
    s_waitcnt lgkmcnt(1)
    v_smfmac_f32_32x32x32_bf16 v[80:95], v[132:135], v[24:31], v7
    ds_read_b128 v[124:127], v5 offset:20640
    v_exp_f32 v37, v37
    v_exp_f32 v38, v38
    v_exp_f32 v39, v39
    v_exp_f32 v40, v40
    v_exp_f32 v41, v41
    v_smfmac_f32_32x32x32_bf16 v[80:95], v[128:131], v[32:39], v7
    ds_read_b128 v[116:119], v4 offset:24768
    v_exp_f32 v42, v42
    v_exp_f32 v43, v43
    v_exp_f32 v44, v44
    v_exp_f32 v45, v45
    v_exp_f32 v46, v46
    v_exp_f32 v47, v47
    v_mfma_f32_32x32x16_bf16 v[64:79], v[120:123], v[112:115], v[96:111]
    ds_read_b128 v[132:135], v6 offset:20640
    v_exp_f32 v48, v48
    v_exp_f32 v49, v49
    v_exp_f32 v50, v50
    v_exp_f32 v51, v51
    v_exp_f32 v52, v52
    s_waitcnt lgkmcnt(1)
    v_smfmac_f32_32x32x32_bf16 v[80:95], v[136:139], v[40:47], v7
    ds_read_b128 v[128:131], v5 offset:22704
    v_exp_f32 v53, v53
    v_exp_f32 v54, v54
    v_exp_f32 v55, v55
    v_exp_f32 v56, v56
    v_exp_f32 v57, v57
    v_smfmac_f32_32x32x32_bf16 v[80:95], v[124:127], v[48:55], v7
    ds_read_b128 v[120:123], v4 offset:26832
    v_exp_f32 v58, v58
    v_exp_f32 v59, v59
    v_exp_f32 v60, v60
    v_exp_f32 v61, v61
    v_exp_f32 v62, v62
    v_exp_f32 v63, v63
    v_mfma_f32_32x32x16_bf16 v[16:31], v[116:119], v[112:115], v[96:111]
    ds_read_b128 v[136:139], v6 offset:22704
    v_exp_f32 v64, v64
    v_exp_f32 v65, v65
    v_exp_f32 v66, v66
    v_exp_f32 v67, v67
    v_exp_f32 v68, v68
    s_waitcnt lgkmcnt(1)
    v_smfmac_f32_32x32x32_bf16 v[80:95], v[132:135], v[56:63], v7
    ds_read_b128 v[124:127], v5 offset:24768
    v_exp_f32 v69, v69
    v_exp_f32 v70, v70
    v_exp_f32 v71, v71
    v_exp_f32 v72, v72
    v_exp_f32 v73, v73
    v_smfmac_f32_32x32x32_bf16 v[80:95], v[128:131], v[64:71], v7
    ds_read_b128 v[116:119], v4 offset:28896
    v_exp_f32 v74, v74
    v_exp_f32 v75, v75
    v_exp_f32 v76, v76
    v_exp_f32 v77, v77
    v_exp_f32 v78, v78
    v_exp_f32 v79, v79
    v_mfma_f32_32x32x16_bf16 v[32:47], v[120:123], v[112:115], v[96:111]
    s_cmp_eq_u32 s69, 1
    s_cbranch_scc1 oo_65
ob_66:
    ds_read_b128 v[132:135], v6 offset:24768
    v_exp_f32 v16, v16
    v_exp_f32 v17, v17
    v_exp_f32 v18, v18
    v_exp_f32 v19, v19
    v_exp_f32 v20, v20
    s_waitcnt lgkmcnt(1)
    v_smfmac_f32_32x32x32_bf16 v[80:95], v[136:139], v[72:79], v7
    ds_read_b128 v[128:131], v5 offset:26832
    v_exp_f32 v21, v21
    v_exp_f32 v22, v22
    v_exp_f32 v23, v23
    v_exp_f32 v24, v24
    v_exp_f32 v25, v25
    v_smfmac_f32_32x32x32_bf16 v[80:95], v[124:127], v[16:23], v7
    ds_read_b128 v[120:123], v4 offset:30960
    v_exp_f32 v26, v26
    v_exp_f32 v27, v27
    v_exp_f32 v28, v28
    v_exp_f32 v29, v29
    v_exp_f32 v30, v30
    v_exp_f32 v31, v31
    v_mfma_f32_32x32x16_bf16 v[48:63], v[116:119], v[112:115], v[96:111]
    ds_read_b128 v[136:139], v6 offset:26832
    v_exp_f32 v32, v32
    v_exp_f32 v33, v33
    v_exp_f32 v34, v34
    v_exp_f32 v35, v35
    v_exp_f32 v36, v36
    s_waitcnt lgkmcnt(1)
    v_smfmac_f32_32x32x32_bf16 v[80:95], v[132:135], v[24:31], v7
    ds_read_b128 v[124:127], v5 offset:28896
    v_exp_f32 v37, v37
    v_exp_f32 v38, v38
    v_exp_f32 v39, v39
    v_exp_f32 v40, v40
    v_exp_f32 v41, v41
    v_smfmac_f32_32x32x32_bf16 v[80:95], v[128:131], v[32:39], v7
    ds_read_b128 v[116:119], v4 offset:33024
    v_exp_f32 v42, v42
    v_exp_f32 v43, v43
    v_exp_f32 v44, v44
    v_exp_f32 v45, v45
    v_exp_f32 v46, v46
    v_exp_f32 v47, v47
    v_mfma_f32_32x32x16_bf16 v[64:79], v[120:123], v[112:115], v[96:111]
    ds_read_b128 v[132:135], v6 offset:28896
    v_exp_f32 v48, v48
    v_exp_f32 v49, v49
    v_exp_f32 v50, v50
    v_exp_f32 v51, v51
    v_exp_f32 v52, v52
    s_waitcnt lgkmcnt(1)
    v_smfmac_f32_32x32x32_bf16 v[80:95], v[136:139], v[40:47], v7
    ds_read_b128 v[128:131], v5 offset:30960
    v_exp_f32 v53, v53
    v_exp_f32 v54, v54
    v_exp_f32 v55, v55
    v_exp_f32 v56, v56
    v_exp_f32 v57, v57
    v_smfmac_f32_32x32x32_bf16 v[80:95], v[124:127], v[48:55], v7
    ds_read_b128 v[120:123], v4 offset:35088
    v_exp_f32 v58, v58
    v_exp_f32 v59, v59
    v_exp_f32 v60, v60
    v_exp_f32 v61, v61
    v_exp_f32 v62, v62
    v_exp_f32 v63, v63
    v_mfma_f32_32x32x16_bf16 v[16:31], v[116:119], v[112:115], v[96:111]
    ds_read_b128 v[136:139], v6 offset:30960
    v_exp_f32 v64, v64
    v_exp_f32 v65, v65
    v_exp_f32 v66, v66
    v_exp_f32 v67, v67
    v_exp_f32 v68, v68
    s_waitcnt lgkmcnt(1)
    v_smfmac_f32_32x32x32_bf16 v[80:95], v[132:135], v[56:63], v7
    ds_read_b128 v[124:127], v5 offset:33024
    v_exp_f32 v69, v69
    v_exp_f32 v70, v70
    v_exp_f32 v71, v71
    v_exp_f32 v72, v72
    v_exp_f32 v73, v73
    v_smfmac_f32_32x32x32_bf16 v[80:95], v[128:131], v[64:71], v7
    ds_read_b128 v[116:119], v4 offset:37152
    v_exp_f32 v74, v74
    v_exp_f32 v75, v75
    v_exp_f32 v76, v76
    v_exp_f32 v77, v77
    v_exp_f32 v78, v78
    v_exp_f32 v79, v79
    v_mfma_f32_32x32x16_bf16 v[32:47], v[120:123], v[112:115], v[96:111]
    v_add_u32 v4, 33024, v4
    v_add_u32 v5, 33024, v5
    v_add_u32 v6, 33024, v6
    s_add_u32 s69, s69, 1
    s_cmp_lt_u32 s69, 4
    s_cbranch_scc1 loop_58
    s_waitcnt lgkmcnt(0)
    v_smfmac_f32_32x32x32_bf16 v[80:95], v[136:139], v[72:79], v7
    s_mov_b32 s72, 0
fin_67:
    s_nop 11
    v_add_f32 v10, v88, v92
    v_rcp_f32 v8, v10
    v_maximum3_f32 v9, v10, abs(v80), abs(v81)
    v_maximum3_f32 v11, abs(v82), abs(v83), abs(v84)
    v_mul_f32 v20, v80, v8
    v_mul_f32 v21, v81, v8
    v_cvt_pk_bf16_f32 v16, v20, v21
    v_mul_f32 v22, v82, v8
    v_mul_f32 v23, v83, v8
    v_cvt_pk_bf16_f32 v17, v22, v23
    v_mul_f32 v24, v84, v8
    v_mul_f32 v25, v85, v8
    v_cvt_pk_bf16_f32 v18, v24, v25
    v_mul_f32 v26, v86, v8
    v_mul_f32 v27, v87, v8
    v_cvt_pk_bf16_f32 v19, v26, v27
    buffer_store_dwordx4 v[16:19], v3, s[4:7], s34 offen sc1
    v_maximum3_f32 v9, v9, abs(v85), abs(v86)
    v_maximum3_f32 v9, v9, v11, abs(v87)
    s_mov_b32 s71, 0x7b800000
    v_cmp_gt_f32 vcc, s71, v9
    s_cmp_lg_u32 s72, 0
    s_cbranch_scc1 store_68
    s_cmp_eq_u64 vcc, exec
    s_cbranch_scc0 fb_69
store_68:
    s_waitcnt vmcnt(0)
    v_mov_b32 v8, 163280
    v_mov_b32 v9, 1
    s_mov_b64 exec, 1
    ds_add_rtn_u32 v9, v8, v9 offset:20
    ds_read_b64 v[10:11], v8
    v_mov_b32 v12, s35
    s_waitcnt lgkmcnt(0)
    v_cmp_eq_u32 vcc, 7, v9
    s_cbranch_vccz sig_70
    buffer_store_dwordx2 v[10:11], v12, s[4:7], 0 offen sc1
sig_70:
    s_mov_b64 exec, -1
    s_endpgm
oo_59:
    s_setprio 0
    s_branch ob_60
oo_61:
    s_mov_b64 exec, 1
    ds_add_u32 v14, v15 offset:56
    s_mov_b64 exec, -1
    s_branch ob_62
oo_63:
    v_mov_b32 v8, 163280
    s_mov_b32 s71, 0
lw_71:
    ds_read_b32 v9, v8 offset:32
    s_add_u32 s71, s71, 1
    s_waitcnt lgkmcnt(0)
    v_cmp_le_u32 vcc, 4, v9
    s_cmp_gt_u32 s71, 480000
    s_cbranch_scc1 lg_72
    s_cbranch_vccnz lg_72
    s_sleep 1
    s_branch lw_71
lg_72:
    s_branch ob_64
oo_65:
    v_mov_b32 v8, 163280
    s_mov_b32 s71, 0
lw_73:
    ds_read_b32 v9, v8 offset:36
    s_add_u32 s71, s71, 1
    s_waitcnt lgkmcnt(0)
    v_cmp_le_u32 vcc, 4, v9
    s_cmp_gt_u32 s71, 480000
    s_cbranch_scc1 lg_74
    s_cbranch_vccnz lg_74
    s_sleep 1
    s_branch lw_73
lg_74:
    s_branch ob_66
fb_69:
    s_mov_b32 s72, 1
    s_lshl_b32 s73, s66, 17
    s_add_u32 s73, s73, 0x200000
    s_mov_b32 s75, s73
    s_mov_b32 s69, 0
    v_mov_b32 v8, 0xff800000
fb1_75:
    buffer_load_dwordx4 v[116:119], v3, s[4:7], s75 offen sc1
    s_add_u32 s75, s75, 2048
    s_waitcnt vmcnt(0)
    v_mfma_f32_32x32x16_bf16 v[16:31], v[116:119], v[112:115], 0
    s_nop 15
    v_max3_f32 v8, v8, v16, v17
    v_max3_f32 v8, v8, v18, v19
    v_max3_f32 v8, v8, v20, v21
    v_max3_f32 v8, v8, v22, v23
    v_max3_f32 v8, v8, v24, v25
    v_max3_f32 v8, v8, v26, v27
    v_max3_f32 v8, v8, v28, v29
    v_max3_f32 v8, v8, v30, v31
    s_add_u32 s69, s69, 1
    s_cmp_lt_u32 s69, 64
    s_cbranch_scc1 fb1_75
    v_mov_b32 v9, v8
    s_nop 1
    v_permlane32_swap_b32 v8, v9
    s_nop 1
    v_max_f32 v8, v8, v9
    v_sub_f32 v96, 0, v8
    v_mov_b32 v80, 0
    v_sub_f32 v97, 0, v8
    v_mov_b32 v81, 0
    v_sub_f32 v98, 0, v8
    v_mov_b32 v82, 0
    v_sub_f32 v99, 0, v8
    v_mov_b32 v83, 0
    v_sub_f32 v100, 0, v8
    v_mov_b32 v84, 0
    v_sub_f32 v101, 0, v8
    v_mov_b32 v85, 0
    v_sub_f32 v102, 0, v8
    v_mov_b32 v86, 0
    v_sub_f32 v103, 0, v8
    v_mov_b32 v87, 0
    v_sub_f32 v104, 0, v8
    v_mov_b32 v88, 0
    v_sub_f32 v105, 0, v8
    v_mov_b32 v89, 0
    v_sub_f32 v106, 0, v8
    v_mov_b32 v90, 0
    v_sub_f32 v107, 0, v8
    v_mov_b32 v91, 0
    v_sub_f32 v108, 0, v8
    v_mov_b32 v92, 0
    v_sub_f32 v109, 0, v8
    v_mov_b32 v93, 0
    v_sub_f32 v110, 0, v8
    v_mov_b32 v94, 0
    v_sub_f32 v111, 0, v8
    v_mov_b32 v95, 0
    v_mov_b32 v124, 0x3f003f00
    v_mov_b32 v132, 0x3f003f00
    v_mov_b32 v125, 0x3f003f00
    v_mov_b32 v133, 0x3f003f00
    v_mov_b32 v126, 0x3f003f00
    v_mov_b32 v134, 0x3f003f00
    v_mov_b32 v127, 0x3f003f00
    v_mov_b32 v135, 0x3f003f00
    s_mov_b32 s75, s73
    s_mov_b32 s69, 0
    s_mov_b32 s76, 0xffff
    s_mov_b32 s77, 0xffff
fb2_76:
    buffer_load_dwordx4 v[116:119], v3, s[4:7], s75 offen sc1
    s_mov_b64 exec, s[76:77]
    buffer_load_dwordx4 v[124:127], v140, s[4:7], s75 offen sc1
    buffer_load_dwordx4 v[132:135], v140, s[4:7], s75 offen offset:512 sc1
    s_mov_b64 exec, -1
    s_add_u32 s75, s75, 2048
    s_waitcnt vmcnt(0)
    v_mfma_f32_32x32x16_bf16 v[16:31], v[116:119], v[112:115], v[96:111]
    s_nop 15
    v_exp_f32 v16, v16
    v_exp_f32 v17, v17
    v_exp_f32 v18, v18
    v_exp_f32 v19, v19
    v_exp_f32 v20, v20
    v_exp_f32 v21, v21
    v_exp_f32 v22, v22
    v_exp_f32 v23, v23
    v_exp_f32 v24, v24
    v_exp_f32 v25, v25
    v_exp_f32 v26, v26
    v_exp_f32 v27, v27
    v_exp_f32 v28, v28
    v_exp_f32 v29, v29
    v_exp_f32 v30, v30
    v_exp_f32 v31, v31
    s_nop 1
    v_smfmac_f32_32x32x32_bf16 v[80:95], v[124:127], v[16:23], v7
    v_smfmac_f32_32x32x32_bf16 v[80:95], v[132:135], v[24:31], v7
    s_nop 15
    s_add_u32 s69, s69, 1
    s_cmp_lt_u32 s69, 64
    s_cbranch_scc1 fb2_76
    s_branch fin_67
xw_2:
    s_setprio 3
    s_sub_u32 s3, s3, 8
    v_lshrrev_b32 v4, 2, v2
    v_and_b32 v5, 3, v2
    v_lshrrev_b32 v16, 3, v2
    s_lshl_b32 s69, s3, 4
    v_add_u32 v16, s69, v16
    s_lshl_b32 s68, s64, 6
    v_add_u32 v17, s68, v16
    v_lshlrev_b32 v17, 10, v17
    v_and_b32 v18, 7, v2
    v_lshrrev_b32 v19, 4, v2
    v_xor_b32 v19, v18, v19
    v_xor_b32 v20, 4, v19
    v_lshl_add_u32 v19, v19, 4, v17
    v_lshl_add_u32 v20, v20, 4, v17
    v_add_u32 v20, 0x2000, v20
    v_mul_u32_u24 v21, 3072, v16
    v_bfe_u32 v22, v2, 4, 1
    v_lshlrev_b32 v22, 2, v22
    v_xor_b32 v22, v22, v18
    v_lshl_add_u32 v21, v22, 4, v21
    s_lshl_b32 s68, s65, 7
    v_add_u32 v21, s68, v21
    s_lshl_b32 s70, s3, 11
    s_add_u32 s71, s70, 65536
    s_lshr_b32 s72, s63, 3
    s_lshl_b32 s72, s72, 1
    s_add_u32 s72, s72, s63
    s_and_b32 s77, s63, 7
    s_lshl_b32 s77, s77, 6
    s_add_u32 s77, s77, s69
    v_and_b32 v23, 15, v2
    v_add_u32 v23, s77, v23
    v_mul_u32_u24 v23, 3072, v23
    v_add_u32 v23, s68, v23
    s_waitcnt lgkmcnt(0)
    s_mov_b32 s8, s48
    s_mov_b32 s9, s49
    s_mov_b32 s10, 0x200000
    s_mov_b32 s11, 0x00020000
    s_mov_b32 s12, s50
    s_mov_b32 s13, s51
    s_mov_b32 s14, 0x180000
    s_mov_b32 s15, 0x00020000
    s_mov_b32 s24, s46
    s_mov_b32 s25, s47
    s_mov_b32 s26, 0x400
    s_mov_b32 s27, 0x00020000
    s_mov_b32 s28, s44
    s_mov_b32 s29, s45
    s_mov_b32 s30, 0x200000
    s_mov_b32 s31, 0x00020000
    s_lshr_b32 s68, s3, 1
    s_and_b32 s69, s3, 1
    s_lshl_b32 s64, s62, 5
    s_add_u32 s64, s64, s63
    s_lshl_b32 s64, s64, 1
    s_add_u32 s65, s64, s68
    s_lshl_b32 s77, s65, 1
    v_mov_b32 v113, s77
    s_lshl_b32 s65, s65, 12
    v_mov_b32 v114, s65
    s_lshl_b32 s77, s69, 1
    s_add_u32 s65, s65, s77
    s_barrier
    s_and_b32 s72, s72, 7
    s_mul_i32 s75, s72, 196608
    s_add_u32 s73, s72, 0
    s_and_b32 s73, s73, 7
    s_lshl_b32 s73, s73, 7
    s_add_u32 m0, s70, 0
    s_nop 0
    buffer_load_dwordx4 v19, s[8:11], s73 offen lds
    s_add_u32 m0, s70, 1024
    s_nop 0
    buffer_load_dwordx4 v20, s[8:11], s73 offen lds
    s_add_u32 m0, s71, 0
    s_add_u32 s76, s75, 1024
    buffer_load_dwordx4 v21, s[12:15], s76 offen lds
    s_add_u32 m0, s71, 1024
    s_add_u32 s76, s75, 25600
    buffer_load_dwordx4 v21, s[12:15], s76 offen lds
    s_add_u32 m0, s71, 8192
    s_add_u32 s76, s75, 2048
    buffer_load_dwordx4 v21, s[12:15], s76 offen lds
    s_add_u32 m0, s71, 9216
    s_add_u32 s76, s75, 26624
    buffer_load_dwordx4 v21, s[12:15], s76 offen lds
    s_add_u32 s72, s72, 1
    s_and_b32 s72, s72, 7
    s_mul_i32 s75, s72, 196608
    s_add_u32 s73, s72, 0
    s_and_b32 s73, s73, 7
    s_lshl_b32 s73, s73, 7
    s_add_u32 m0, s70, 8192
    s_nop 0
    buffer_load_dwordx4 v19, s[8:11], s73 offen lds
    s_add_u32 m0, s70, 9216
    s_nop 0
    buffer_load_dwordx4 v20, s[8:11], s73 offen lds
    s_mov_b64 exec, 0xffff
    buffer_load_dword v146, v23, s[12:15], 0 offen
    s_mov_b64 exec, -1
    s_add_u32 m0, s71, 16384
    s_add_u32 s76, s75, 1024
    buffer_load_dwordx4 v21, s[12:15], s76 offen lds
    s_add_u32 m0, s71, 17408
    s_add_u32 s76, s75, 25600
    buffer_load_dwordx4 v21, s[12:15], s76 offen lds
    s_add_u32 m0, s71, 24576
    s_add_u32 s76, s75, 2048
    buffer_load_dwordx4 v21, s[12:15], s76 offen lds
    s_add_u32 m0, s71, 25600
    s_add_u32 s76, s75, 26624
    buffer_load_dwordx4 v21, s[12:15], s76 offen lds
    s_add_u32 s72, s72, 1
    buffer_load_dwordx4 v[128:131], v3, s[28:31], s65 offen
    buffer_load_dwordx4 v[132:135], v3, s[28:31], s65 offen offset:1024
    buffer_load_dwordx4 v[136:139], v3, s[28:31], s65 offen offset:2048
    buffer_load_dwordx4 v[140:143], v3, s[28:31], s65 offen offset:3072
    buffer_load_ushort v144, v113, s[24:27], 0 offen
    buffer_load_ushort v145, v114, s[28:31], 0 offen
    s_and_b32 s72, s72, 7
    s_mul_i32 s75, s72, 196608
    s_add_u32 s73, s72, 0
    s_and_b32 s73, s73, 7
    s_lshl_b32 s73, s73, 7
    s_add_u32 m0, s70, 16384
    s_nop 0
    buffer_load_dwordx4 v19, s[8:11], s73 offen lds
    s_add_u32 m0, s70, 17408
    s_nop 0
    buffer_load_dwordx4 v20, s[8:11], s73 offen lds
    s_add_u32 m0, s71, 32768
    s_add_u32 s76, s75, 1024
    buffer_load_dwordx4 v21, s[12:15], s76 offen lds
    s_add_u32 m0, s71, 33792
    s_add_u32 s76, s75, 25600
    buffer_load_dwordx4 v21, s[12:15], s76 offen lds
    s_add_u32 m0, s71, 40960
    s_add_u32 s76, s75, 2048
    buffer_load_dwordx4 v21, s[12:15], s76 offen lds
    s_add_u32 m0, s71, 41984
    s_add_u32 s76, s75, 26624
    buffer_load_dwordx4 v21, s[12:15], s76 offen lds
    s_add_u32 s72, s72, 1
    s_add_u32 s20, s58, 0x600000
    s_addc_u32 s21, s59, 0
    s_mov_b32 s22, 0x200000
    s_mov_b32 s23, 0x00020000
    v_mul_u32_u24 v23, 57, v2
    v_lshrrev_b32 v23, 9, v23
    v_mul_u32_u24 v24, 9, v23
    v_sub_u32 v24, v2, v24
    v_lshrrev_b32 v25, 1, v24
    v_lshl_add_u32 v25, v23, 2, v25
    v_lshlrev_b32 v25, 9, v25
    v_and_b32 v24, 1, v24
    v_add_u32 v25, v25, v24
    v_add_u32 v25, s64, v25
    v_lshlrev_b32 v25, 4, v25
    s_mov_b32 s74, 0
    v_mov_b32 v28, 163280
    s_waitcnt vmcnt(19)
    s_barrier
    s_and_b32 s72, s72, 7
    s_mul_i32 s75, s72, 196608
    s_add_u32 s73, s72, 0
    s_and_b32 s73, s73, 7
    s_lshl_b32 s73, s73, 7
    s_add_u32 m0, s70, 24576
    s_nop 0
    buffer_load_dwordx4 v19, s[8:11], s73 offen lds
    s_add_u32 m0, s70, 25600
    s_nop 0
    buffer_load_dwordx4 v20, s[8:11], s73 offen lds
    s_add_u32 m0, s71, 49152
    s_add_u32 s76, s75, 1024
    buffer_load_dwordx4 v21, s[12:15], s76 offen lds
    s_add_u32 m0, s71, 50176
    s_add_u32 s76, s75, 25600
    buffer_load_dwordx4 v21, s[12:15], s76 offen lds
    s_add_u32 m0, s71, 57344
    s_add_u32 s76, s75, 2048
    buffer_load_dwordx4 v21, s[12:15], s76 offen lds
    s_add_u32 m0, s71, 58368
    s_add_u32 s76, s75, 26624
    buffer_load_dwordx4 v21, s[12:15], s76 offen lds
    s_add_u32 s72, s72, 1
    s_waitcnt vmcnt(18)
    s_barrier
    s_and_b32 s72, s72, 7
    s_mul_i32 s75, s72, 196608
    s_add_u32 s73, s72, 0
    s_and_b32 s73, s73, 7
    s_lshl_b32 s73, s73, 7
    s_add_u32 m0, s70, 32768
    s_nop 0
    buffer_load_dwordx4 v19, s[8:11], s73 offen lds
    s_add_u32 m0, s70, 33792
    s_nop 0
    buffer_load_dwordx4 v20, s[8:11], s73 offen lds
    s_add_u32 m0, s71, 0
    s_add_u32 s76, s75, 1024
    buffer_load_dwordx4 v21, s[12:15], s76 offen lds
    s_add_u32 m0, s71, 1024
    s_add_u32 s76, s75, 25600
    buffer_load_dwordx4 v21, s[12:15], s76 offen lds
    s_add_u32 m0, s71, 8192
    s_add_u32 s76, s75, 2048
    buffer_load_dwordx4 v21, s[12:15], s76 offen lds
    s_add_u32 m0, s71, 9216
    s_add_u32 s76, s75, 26624
    buffer_load_dwordx4 v21, s[12:15], s76 offen lds
    s_add_u32 s72, s72, 1
    s_waitcnt vmcnt(12)
    s_barrier
    s_and_b32 s72, s72, 7
    s_mul_i32 s75, s72, 196608
    s_add_u32 s73, s72, 0
    s_and_b32 s73, s73, 7
    s_lshl_b32 s73, s73, 7
    s_add_u32 m0, s70, 40960
    s_nop 0
    buffer_load_dwordx4 v19, s[8:11], s73 offen lds
    s_add_u32 m0, s70, 41984
    s_nop 0
    buffer_load_dwordx4 v20, s[8:11], s73 offen lds
    s_add_u32 m0, s71, 16384
    s_add_u32 s76, s75, 1024
    buffer_load_dwordx4 v21, s[12:15], s76 offen lds
    s_add_u32 m0, s71, 17408
    s_add_u32 s76, s75, 25600
    buffer_load_dwordx4 v21, s[12:15], s76 offen lds
    s_add_u32 m0, s71, 24576
    s_add_u32 s76, s75, 2048
    buffer_load_dwordx4 v21, s[12:15], s76 offen lds
    s_add_u32 m0, s71, 25600
    s_add_u32 s76, s75, 26624
    buffer_load_dwordx4 v21, s[12:15], s76 offen lds
    s_add_u32 s72, s72, 1
    s_waitcnt vmcnt(12)
    s_barrier
    s_and_b32 s72, s72, 7
    s_mul_i32 s75, s72, 196608
    s_add_u32 s73, s72, 0
    s_and_b32 s73, s73, 7
    s_lshl_b32 s73, s73, 7
    s_add_u32 m0, s70, 49152
    s_nop 0
    buffer_load_dwordx4 v19, s[8:11], s73 offen lds
    s_add_u32 m0, s70, 50176
    s_nop 0
    buffer_load_dwordx4 v20, s[8:11], s73 offen lds
    s_add_u32 m0, s71, 32768
    s_add_u32 s76, s75, 1024
    buffer_load_dwordx4 v21, s[12:15], s76 offen lds
    s_add_u32 m0, s71, 33792
    s_add_u32 s76, s75, 25600
    buffer_load_dwordx4 v21, s[12:15], s76 offen lds
    s_add_u32 m0, s71, 40960
    s_add_u32 s76, s75, 2048
    buffer_load_dwordx4 v21, s[12:15], s76 offen lds
    s_add_u32 m0, s71, 41984
    s_add_u32 s76, s75, 26624
    buffer_load_dwordx4 v21, s[12:15], s76 offen lds
    s_add_u32 s72, s72, 1
    s_waitcnt vmcnt(12)
    s_barrier
    s_and_b32 s72, s72, 7
    s_mul_i32 s75, s72, 196608
    s_add_u32 s73, s72, 0
    s_and_b32 s73, s73, 7
    s_lshl_b32 s73, s73, 7
    s_add_u32 m0, s70, 57344
    s_nop 0
    buffer_load_dwordx4 v19, s[8:11], s73 offen lds
    s_add_u32 m0, s70, 58368
    s_nop 0
    buffer_load_dwordx4 v20, s[8:11], s73 offen lds
    s_add_u32 m0, s71, 49152
    s_add_u32 s76, s75, 1024
    buffer_load_dwordx4 v21, s[12:15], s76 offen lds
    s_add_u32 m0, s71, 50176
    s_add_u32 s76, s75, 25600
    buffer_load_dwordx4 v21, s[12:15], s76 offen lds
    s_add_u32 m0, s71, 57344
    s_add_u32 s76, s75, 2048
    buffer_load_dwordx4 v21, s[12:15], s76 offen lds
    s_add_u32 m0, s71, 58368
    s_add_u32 s76, s75, 26624
    buffer_load_dwordx4 v21, s[12:15], s76 offen lds
    s_add_u32 s72, s72, 1
    s_waitcnt vmcnt(12)
    s_barrier
    s_and_b32 s72, s72, 7
    s_mul_i32 s75, s72, 196608
    s_add_u32 m0, s70, 131072
    s_add_u32 s76, s75, 0
    buffer_load_dwordx4 v21, s[12:15], s76 offen lds
    s_add_u32 m0, s70, 132096
    s_add_u32 s76, s75, 24576
    buffer_load_dwordx4 v21, s[12:15], s76 offen lds
    s_add_u32 s72, s72, 1
    s_and_b32 s72, s72, 7
    s_mul_i32 s75, s72, 196608
    s_add_u32 m0, s70, 139264
    s_add_u32 s76, s75, 0
    buffer_load_dwordx4 v21, s[12:15], s76 offen lds
    s_add_u32 m0, s70, 140288
    s_add_u32 s76, s75, 24576
    buffer_load_dwordx4 v21, s[12:15], s76 offen lds
    s_add_u32 s72, s72, 1
    s_and_b32 s72, s72, 7
    s_mul_i32 s75, s72, 196608
    s_add_u32 m0, s70, 65536
    s_add_u32 s76, s75, 0
    buffer_load_dwordx4 v21, s[12:15], s76 offen lds
    s_add_u32 m0, s70, 66560
    s_add_u32 s76, s75, 24576
    buffer_load_dwordx4 v21, s[12:15], s76 offen lds
    s_add_u32 s72, s72, 1
    s_and_b32 s72, s72, 7
    s_mul_i32 s75, s72, 196608
    s_add_u32 m0, s70, 73728
    s_add_u32 s76, s75, 0
    buffer_load_dwordx4 v21, s[12:15], s76 offen lds
    s_add_u32 m0, s70, 74752
    s_add_u32 s76, s75, 24576
    buffer_load_dwordx4 v21, s[12:15], s76 offen lds
    s_add_u32 s72, s72, 1
    s_waitcnt vmcnt(14)
    s_barrier
    s_and_b32 s72, s72, 7
    s_mul_i32 s75, s72, 196608
    s_add_u32 m0, s70, 81920
    s_add_u32 s76, s75, 0
    buffer_load_dwordx4 v21, s[12:15], s76 offen lds
    s_add_u32 m0, s70, 82944
    s_add_u32 s76, s75, 24576
    buffer_load_dwordx4 v21, s[12:15], s76 offen lds
    s_add_u32 s72, s72, 1
    s_and_b32 s72, s72, 7
    s_mul_i32 s75, s72, 196608
    s_add_u32 m0, s70, 90112
    s_add_u32 s76, s75, 0
    buffer_load_dwordx4 v21, s[12:15], s76 offen lds
    s_add_u32 m0, s70, 91136
    s_add_u32 s76, s75, 24576
    buffer_load_dwordx4 v21, s[12:15], s76 offen lds
    s_add_u32 s72, s72, 1
    s_waitcnt vmcnt(12)
    s_barrier
    s_and_b32 s72, s72, 7
    s_mul_i32 s75, s72, 196608
    s_add_u32 m0, s70, 98304
    s_add_u32 s76, s75, 0
    buffer_load_dwordx4 v21, s[12:15], s76 offen lds
    s_add_u32 m0, s70, 99328
    s_add_u32 s76, s75, 24576
    buffer_load_dwordx4 v21, s[12:15], s76 offen lds
    s_add_u32 s72, s72, 1
    s_and_b32 s72, s72, 7
    s_mul_i32 s75, s72, 196608
    s_add_u32 m0, s70, 106496
    s_add_u32 s76, s75, 0
    buffer_load_dwordx4 v21, s[12:15], s76 offen lds
    s_add_u32 m0, s70, 107520
    s_add_u32 s76, s75, 24576
    buffer_load_dwordx4 v21, s[12:15], s76 offen lds
    s_add_u32 s72, s72, 1
    s_waitcnt vmcnt(12)
    v_mov_b32 v28, 163280
    v_mov_b32 v29, 1
    s_mov_b64 exec, 1
    ds_add_u32 v28, v29 offset:92
    s_mov_b64 exec, -1
    s_waitcnt vmcnt(8)
    v_mov_b32 v28, 163280
    v_mov_b32 v29, 1
    s_mov_b64 exec, 1
    ds_add_u32 v28, v29 offset:92
    s_mov_b64 exec, -1
    s_waitcnt vmcnt(4)
    v_mov_b32 v28, 163280
    v_mov_b32 v29, 1
    s_mov_b64 exec, 1
    ds_add_u32 v28, v29 offset:92
    s_mov_b64 exec, -1
    s_waitcnt vmcnt(0)
    v_mov_b32 v28, 163280
    v_mov_b32 v29, 1
    s_mov_b64 exec, 1
    ds_add_u32 v28, v29 offset:92
    s_mov_b64 exec, -1
    s_cmp_lg_u32 s74, 0
    s_cbranch_scc1 xj_77
    v_mov_b32 v28, 163280
    s_mov_b32 s79, 0
lw_78:
    ds_read_b32 v29, v28 offset:48
    s_add_u32 s79, s79, 1
    s_waitcnt lgkmcnt(0)
    v_cmp_le_u32 vcc, 1, v29
    s_cmp_gt_u32 s79, 480000
    s_cbranch_scc1 lg_79
    s_cbranch_vccnz lg_79
    s_sleep 1
    s_branch lw_78
lg_79:
    s_mul_i32 s77, s3, 196608
    s_mul_i32 s78, s3, 864
    s_add_u32 s78, s78, 149152
    s_mov_b32 exec_hi, 0x3fffff
    s_add_u32 m0, s78, 0
    s_add_u32 s76, s77, 0
    buffer_load_dwordx4 v25, s[20:23], s76 offen sc1 lds
    s_add_u32 m0, s78, 3456
    s_add_u32 s76, s77, 786432
    buffer_load_dwordx4 v25, s[20:23], s76 offen sc1 lds
    s_add_u32 m0, s78, 6912
    s_add_u32 s76, s77, 1572864
    buffer_load_dwordx4 v25, s[20:23], s76 offen sc1 lds
    s_add_u32 m0, s78, 10368
    s_add_u32 s76, s77, 2359296
    buffer_load_dwordx4 v25, s[20:23], s76 offen sc1 lds
    s_mov_b32 exec_hi, -1
xj_77:
    s_mov_b32 s4, s58
    s_mov_b32 s5, s59
    s_mov_b32 s6, 0xc10000
    s_mov_b32 s7, 0x00020000
    s_mov_b32 s8, s36
    s_mov_b32 s9, s37
    s_mov_b32 s10, 0x200000
    s_mov_b32 s11, 0x00020000
    s_mov_b32 s12, s52
    s_mov_b32 s13, s53
    s_mov_b32 s14, 0x80000
    s_mov_b32 s15, 0x00020000
    s_mov_b32 s32, s54
    s_mov_b32 s33, s55
    s_mov_b32 s34, 0x400000
    s_mov_b32 s35, 0x00020000
    v_mov_b32 v100, 163280
    ds_read_b64 v[102:103], v100
    s_waitcnt lgkmcnt(0)
    v_readfirstlane_b32 s60, v102
    v_readfirstlane_b32 s61, v103
    v_and_b32 v20, 31, v2
    v_lshrrev_b32 v21, 5, v2
    v_lshlrev_b32 v11, 10, v4
    v_lshl_add_u32 v11, v5, 4, v11
    s_mul_i32 s78, s68, 8528
    s_add_u32 s78, s78, 132096
    v_mul_u32_u24 v111, 4292, v21
    v_lshl_add_u32 v111, v20, 2, v111
    v_add_u32 v111, s78, v111
    s_mul_i32 s76, s69, 4292
    s_add_u32 s76, s76, s78
    s_add_u32 s76, s76, 128
    v_add_u32 v112, s76, v3
    s_lshl_b32 s70, s66, 17
    s_add_u32 s70, s70, 0x200000
    s_lshl_b32 s71, s3, 10
    s_add_u32 s70, s70, s71
    s_mul_i32 s74, s68, 2064
    s_lshl_b32 s75, s69, 10
    s_add_u32 s74, s74, s75
    s_lshl_b32 s75, s67, 14
    v_mul_u32_u24 v26, 2064, v2
    v_mov_b32 v116, 0x3f803f80
    v_mov_b32 v117, 0x3f803f80
    v_mov_b32 v118, 0x3f803f80
    v_mov_b32 v119, 0x3f803f80
    s_lshr_b32 s68, s63, 1
    s_lshl_b32 s68, s68, 2
    s_add_u32 s68, s68, s3
    s_and_b32 s69, s63, 1
    s_lshl_b32 s77, s62, 1
    s_add_u32 s69, s69, s77
    v_lshlrev_b32 v16, 16, v144
    v_lshlrev_b32 v17, 16, v145
    v_mov_b32 v110, 0
    v_cmp_eq_u32 vcc, 16, v2
    s_nop 1
    v_cndmask_b32 v110, v110, v144, vcc
    v_cmp_eq_u32 vcc, 47, v2
    s_nop 1
    v_cndmask_b32 v110, v110, v16, vcc
    v_cmp_eq_u32 vcc, 63, v2
    s_nop 1
    v_cndmask_b32 v110, v110, v17, vcc
    v_mov_b32 v28, 163280
    s_mov_b32 s79, 0
lw_80:
    ds_read_b32 v29, v28 offset:100
    s_add_u32 s79, s79, 1
    s_waitcnt lgkmcnt(0)
    v_cmp_le_u32 vcc, 4, v29
    s_cmp_gt_u32 s79, 480000
    s_cbranch_scc1 lg_81
    s_cbranch_vccnz lg_81
    s_sleep 1
    s_branch lw_80
lg_81:
    ds_write_b128 v112, v[128:131]
    ds_write_b128 v112, v[132:135] offset:1024
    ds_write_b128 v112, v[136:139] offset:2048
    ds_write_b128 v112, v[140:143] offset:3072
    ds_write_b32 v111, v110
    s_waitcnt vmcnt(0) lgkmcnt(0)
    v_mov_b32 v28, 163280
    v_mov_b32 v29, 1
    s_mov_b64 exec, 1
    ds_add_u32 v28, v29 offset:40
    s_mov_b64 exec, -1
    s_lshr_b32 s72, s3, 1
    s_and_b32 s73, s3, 1
    s_lshl_b32 s76, s72, 14
    s_lshl_b32 s78, s73, 12
    s_add_u32 s76, s76, s78
    s_add_u32 s76, s76, 82560
    v_add_u32 v23, s76, v3
    s_mul_i32 s76, s3, 2560
    s_add_u32 s76, s76, 132096
    v_mul_u32_u24 v160, 80, v20
    v_lshl_add_u32 v160, v21, 3, v160
    v_add_u32 v160, s76, v160
    v_mul_u32_u24 v15, 80, v4
    v_lshl_add_u32 v15, v5, 4, v15
    v_add_u32 v161, s76, v15
    s_mul_i32 s77, s3, 4608
    s_add_u32 s77, s77, 132096
    v_lshlrev_b32 v10, 12, v4
    v_lshl_add_u32 v10, v5, 4, v10
    v_lshrrev_b32 v12, 4, v2
    v_and_b32 v9, 3, v4
    v_lshl_add_u32 v13, v12, 3, v9
    v_lshlrev_b32 v13, 6, v13
    v_lshl_add_u32 v13, v5, 3, v13
    v_add_u32 v13, s77, v13
    v_and_b32 v14, 15, v2
    v_mul_u32_u24 v14, 80, v14
    v_lshl_add_u32 v14, v12, 4, v14
    s_add_u32 s76, s77, 2048
    v_add_u32 v14, s76, v14
    v_add_u32 v15, s76, v15
    v_lshlrev_b32 v162, 11, v4
    v_lshl_add_u32 v162, v5, 4, v162
    s_lshr_b32 s76, s63, 2
    s_lshl_b32 s76, s76, 7
    v_lshrrev_b32 v6, 3, v2
    s_lshl_b32 s78, s3, 7
    v_add_u32 v7, s78, v6
    v_lshlrev_b32 v7, 10, v7
    v_bfe_u32 v8, v2, 4, 1
    v_lshlrev_b32 v12, 2, v8
    v_and_b32 v6, 7, v2
    v_xor_b32 v12, v12, v6
    v_lshl_add_u32 v7, v12, 4, v7
    v_add_u32 v7, s76, v7
    v_lshl_add_u32 v163, v21, 2, v9
    v_lshlrev_b32 v163, 7, v163
    v_lshrrev_b32 v12, 1, v9
    v_xor_b32 v12, s72, v12
    v_lshl_add_u32 v163, v12, 6, v163
    v_lshl_add_u32 v163, v8, 5, v163
    v_lshl_add_u32 v163, v5, 3, v163
    s_lshl_b32 s76, s73, 15
    s_add_u32 s76, s76, 66560
    v_add_u32 v164, s76, v3
    v_and_b32 v8, 1, v2
    v_add_u32 v9, v20, v8
    v_lshlrev_b32 v9, 1, v9
    v_lshl_add_u32 v9, v21, 4, v9
    v_xor_b32 v8, 1, v8
    v_mul_u32_u24 v8, 4292, v8
    v_add_u32 v9, v9, v8
    s_mul_i32 s76, s72, 8528
    s_lshl_b32 s78, s73, 11
    s_add_u32 s76, s76, s78
    s_add_u32 s76, s76, 132160
    v_add_u32 v165, s76, v9
    v_add_u32 v166, 0x400, v165
    v_sub_u32 v167, 63, v20
    v_mul_u32_u24 v167, 144, v167
    v_lshl_add_u32 v167, v21, 5, v167
    s_lshl_b32 s76, s72, 4
    s_add_u32 s76, s76, 149152
    v_add_u32 v167, s76, v167
    v_mov_b32 v28, 163280
    s_mov_b32 s79, 0
lw_82:
    ds_read_b32 v29, v28 offset:96
    s_add_u32 s79, s79, 1
    s_waitcnt lgkmcnt(0)
    v_cmp_le_u32 vcc, 4, v29
    s_cmp_gt_u32 s79, 480000
    s_cbranch_scc1 lg_83
    s_cbranch_vccnz lg_83
    s_sleep 1
    s_branch lw_82
lg_83:
    v_mov_b32 v28, 163280
    s_mov_b32 s79, 0
lw_84:
    ds_read_b32 v29, v28 offset:8
    s_add_u32 s79, s79, 1
    s_waitcnt lgkmcnt(0)
    v_cmp_le_u32 vcc, 8, v29
    s_cmp_gt_u32 s79, 480000
    s_cbranch_scc1 lg_85
    s_cbranch_vccnz lg_85
    s_sleep 1
    s_branch lw_84
lg_85:
    s_mov_b32 exec_hi, 0
    ds_write_b128 v26, v[116:119] offset:2048
    s_mov_b32 exec_hi, -1
    s_cmp_lg_u32 s3, 0
    s_cbranch_scc1 lpo_86
    s_lshr_b32 s78, s66, 2
    s_lshl_b32 s78, s78, 8
    s_add_u32 s78, s78, 0xc00000
    v_and_b32 v30, 31, v2
    v_lshlrev_b32 v30, 3, v30
    s_mov_b32 s79, 0
poll_88:
    buffer_load_dwordx2 v[28:29], v30, s[4:7], s78 offen sc1
    s_add_u32 s79, s79, 1
    s_waitcnt vmcnt(0)
    v_cmp_eq_u64 vcc, s[60:61], v[28:29]
    s_cmp_gt_u32 s79, 30000
    s_cbranch_scc1 pgo_89
    s_cmp_eq_u64 vcc, exec
    s_cbranch_scc1 pgo_89
    s_sleep 1
    s_branch poll_88
pgo_89:
    v_mov_b32 v28, 163280
    v_mov_b32 v29, 1
    s_mov_b64 exec, 1
    ds_add_u32 v28, v29 offset:44
    s_mov_b64 exec, -1
    s_branch lpd_87
lpo_86:
    v_mov_b32 v28, 163280
    s_mov_b32 s79, 0
lw_90:
    ds_read_b32 v29, v28 offset:44
    s_add_u32 s79, s79, 1
    s_waitcnt lgkmcnt(0)
    v_cmp_le_u32 vcc, 1, v29
    s_cmp_gt_u32 s79, 480000
    s_cbranch_scc1 lg_91
    s_cbranch_vccnz lg_91
    s_sleep 1
    s_branch lw_90
lg_91:
lpd_87:
    s_and_b32 s75, s75, 0x1ffff
    s_add_u32 m0, s74, 0
    s_add_u32 s76, s70, s75
    buffer_load_dwordx4 v3, s[4:7], s76 offen sc1 lds
    s_add_u32 s75, s75, 4096
    s_and_b32 s75, s75, 0x1ffff
    s_add_u32 m0, s74, 4128
    s_add_u32 s76, s70, s75
    buffer_load_dwordx4 v3, s[4:7], s76 offen sc1 lds
    s_add_u32 s75, s75, 4096
    s_and_b32 s75, s75, 0x1ffff
    s_add_u32 m0, s74, 8256
    s_add_u32 s76, s70, s75
    buffer_load_dwordx4 v3, s[4:7], s76 offen sc1 lds
    s_add_u32 s75, s75, 4096
    s_and_b32 s75, s75, 0x1ffff
    s_add_u32 m0, s74, 12384
    s_add_u32 s76, s70, s75
    buffer_load_dwordx4 v3, s[4:7], s76 offen sc1 lds
    s_add_u32 s75, s75, 4096
    s_waitcnt vmcnt(0)
    v_mov_b32 v28, 163280
    v_mov_b32 v29, 1
    s_mov_b64 exec, 1
    ds_add_u32 v28, v29 offset:28
    s_mov_b64 exec, -1
    s_and_b32 s75, s75, 0x1ffff
    s_add_u32 m0, s74, 16512
    s_add_u32 s76, s70, s75
    buffer_load_dwordx4 v3, s[4:7], s76 offen sc1 lds
    s_add_u32 s75, s75, 4096
    s_and_b32 s75, s75, 0x1ffff
    s_add_u32 m0, s74, 20640
    s_add_u32 s76, s70, s75
    buffer_load_dwordx4 v3, s[4:7], s76 offen sc1 lds
    s_add_u32 s75, s75, 4096
    s_and_b32 s75, s75, 0x1ffff
    s_add_u32 m0, s74, 24768
    s_add_u32 s76, s70, s75
    buffer_load_dwordx4 v3, s[4:7], s76 offen sc1 lds
    s_add_u32 s75, s75, 4096
    s_and_b32 s75, s75, 0x1ffff
    s_add_u32 m0, s74, 28896
    s_add_u32 s76, s70, s75
    buffer_load_dwordx4 v3, s[4:7], s76 offen sc1 lds
    s_add_u32 s75, s75, 4096
    s_and_b32 s75, s75, 0x1ffff
    s_add_u32 m0, s74, 33024
    s_add_u32 s76, s70, s75
    buffer_load_dwordx4 v3, s[4:7], s76 offen sc1 lds
    s_add_u32 s75, s75, 4096
    s_and_b32 s75, s75, 0x1ffff
    s_add_u32 m0, s74, 37152
    s_add_u32 s76, s70, s75
    buffer_load_dwordx4 v3, s[4:7], s76 offen sc1 lds
    s_add_u32 s75, s75, 4096
    s_and_b32 s75, s75, 0x1ffff
    s_add_u32 m0, s74, 41280
    s_add_u32 s76, s70, s75
    buffer_load_dwordx4 v3, s[4:7], s76 offen sc1 lds
    s_add_u32 s75, s75, 4096
    s_and_b32 s75, s75, 0x1ffff
    s_add_u32 m0, s74, 45408
    s_add_u32 s76, s70, s75
    buffer_load_dwordx4 v3, s[4:7], s76 offen sc1 lds
    s_add_u32 s75, s75, 4096
    s_and_b32 s75, s75, 0x1ffff
    s_add_u32 m0, s74, 49536
    s_add_u32 s76, s70, s75
    buffer_load_dwordx4 v3, s[4:7], s76 offen sc1 lds
    s_add_u32 s75, s75, 4096
    s_and_b32 s75, s75, 0x1ffff
    s_add_u32 m0, s74, 53664
    s_add_u32 s76, s70, s75
    buffer_load_dwordx4 v3, s[4:7], s76 offen sc1 lds
    s_add_u32 s75, s75, 4096
    s_and_b32 s75, s75, 0x1ffff
    s_add_u32 m0, s74, 57792
    s_add_u32 s76, s70, s75
    buffer_load_dwordx4 v3, s[4:7], s76 offen sc1 lds
    s_add_u32 s75, s75, 4096
    s_and_b32 s75, s75, 0x1ffff
    s_add_u32 m0, s74, 61920
    s_add_u32 s76, s70, s75
    buffer_load_dwordx4 v3, s[4:7], s76 offen sc1 lds
    s_add_u32 s75, s75, 4096
    s_waitcnt vmcnt(0)
    v_mov_b32 v28, 163280
    v_mov_b32 v29, 1
    s_mov_b64 exec, 1
    ds_add_u32 v28, v29 offset:32
    s_mov_b64 exec, -1
    s_add_u32 s77, s64, s72
    s_lshl_b32 s77, s77, 12
    s_lshl_b32 s78, s73, 11
    s_add_u32 s77, s77, s78
    s_add_u32 s77, s77, 0xa00000
    v_mov_b32 v28, 163280
    s_mov_b32 s79, 0
lw_92:
    ds_read_b32 v29, v28 offset:104
    s_add_u32 s79, s79, 1
    s_waitcnt lgkmcnt(0)
    v_cmp_le_u32 vcc, 4, v29
    s_cmp_gt_u32 s79, 480000
    s_cbranch_scc1 lg_93
    s_cbranch_vccnz lg_93
    s_sleep 2
    s_branch lw_92
lg_93:
    ds_read_b128 v[32:35], v23 offset:0
    ds_read_b128 v[48:51], v23 offset:8192
    ds_read_b128 v[36:39], v23 offset:1024
    ds_read_b128 v[52:55], v23 offset:9216
    ds_read_b128 v[40:43], v23 offset:2048
    ds_read_b128 v[56:59], v23 offset:10240
    ds_read_b128 v[44:47], v23 offset:3072
    ds_read_b128 v[60:63], v23 offset:11264
    s_waitcnt lgkmcnt(0)
    v_mov_b32 v28, 163280
    v_mov_b32 v29, 1
    s_mov_b64 exec, 1
    ds_add_u32 v28, v29 offset:104
    s_mov_b64 exec, -1
    v_add_f32 v32, v32, v48
    v_add_f32 v33, v33, v49
    v_add_f32 v34, v34, v50
    v_add_f32 v35, v35, v51
    v_add_f32 v36, v36, v52
    v_add_f32 v37, v37, v53
    v_add_f32 v38, v38, v54
    v_add_f32 v39, v39, v55
    v_add_f32 v40, v40, v56
    v_add_f32 v41, v41, v57
    v_add_f32 v42, v42, v58
    v_add_f32 v43, v43, v59
    v_add_f32 v44, v44, v60
    v_add_f32 v45, v45, v61
    v_add_f32 v46, v46, v62
    v_add_f32 v47, v47, v63
    v_mov_b32 v28, 163280
    s_mov_b32 s79, 0
lw_94:
    ds_read_b32 v29, v28 offset:104
    s_add_u32 s79, s79, 1
    s_waitcnt lgkmcnt(0)
    v_cmp_le_u32 vcc, 8, v29
    s_cmp_gt_u32 s79, 480000
    s_cbranch_scc1 lg_95
    s_cbranch_vccnz lg_95
    s_sleep 1
    s_branch lw_94
lg_95:
    ds_write_b128 v26, v[116:119] offset:2048
    s_and_b32 s75, s75, 0x1ffff
    s_add_u32 m0, s74, 66048
    s_add_u32 s76, s70, s75
    buffer_load_dwordx4 v3, s[4:7], s76 offen sc1 lds
    s_add_u32 s75, s75, 4096
    s_and_b32 s75, s75, 0x1ffff
    s_add_u32 m0, s74, 70176
    s_add_u32 s76, s70, s75
    buffer_load_dwordx4 v3, s[4:7], s76 offen sc1 lds
    s_add_u32 s75, s75, 4096
    s_and_b32 s75, s75, 0x1ffff
    s_add_u32 m0, s74, 74304
    s_add_u32 s76, s70, s75
    buffer_load_dwordx4 v3, s[4:7], s76 offen sc1 lds
    s_add_u32 s75, s75, 4096
    s_and_b32 s75, s75, 0x1ffff
    s_add_u32 m0, s74, 78432
    s_add_u32 s76, s70, s75
    buffer_load_dwordx4 v3, s[4:7], s76 offen sc1 lds
    s_add_u32 s75, s75, 4096
    s_and_b32 s75, s75, 0x1ffff
    s_add_u32 m0, s74, 82560
    s_add_u32 s76, s70, s75
    buffer_load_dwordx4 v3, s[4:7], s76 offen sc1 lds
    s_add_u32 s75, s75, 4096
    s_and_b32 s75, s75, 0x1ffff
    s_add_u32 m0, s74, 86688
    s_add_u32 s76, s70, s75
    buffer_load_dwordx4 v3, s[4:7], s76 offen sc1 lds
    s_add_u32 s75, s75, 4096
    s_and_b32 s75, s75, 0x1ffff
    s_add_u32 m0, s74, 90816
    s_add_u32 s76, s70, s75
    buffer_load_dwordx4 v3, s[4:7], s76 offen sc1 lds
    s_add_u32 s75, s75, 4096
    s_and_b32 s75, s75, 0x1ffff
    s_add_u32 m0, s74, 94944
    s_add_u32 s76, s70, s75
    buffer_load_dwordx4 v3, s[4:7], s76 offen sc1 lds
    s_add_u32 s75, s75, 4096
    s_and_b32 s75, s75, 0x1ffff
    s_add_u32 m0, s74, 99072
    s_add_u32 s76, s70, s75
    buffer_load_dwordx4 v3, s[4:7], s76 offen sc1 lds
    s_add_u32 s75, s75, 4096
    s_and_b32 s75, s75, 0x1ffff
    s_add_u32 m0, s74, 103200
    s_add_u32 s76, s70, s75
    buffer_load_dwordx4 v3, s[4:7], s76 offen sc1 lds
    s_add_u32 s75, s75, 4096
    s_and_b32 s75, s75, 0x1ffff
    s_add_u32 m0, s74, 107328
    s_add_u32 s76, s70, s75
    buffer_load_dwordx4 v3, s[4:7], s76 offen sc1 lds
    s_add_u32 s75, s75, 4096
    s_and_b32 s75, s75, 0x1ffff
    s_add_u32 m0, s74, 111456
    s_add_u32 s76, s70, s75
    buffer_load_dwordx4 v3, s[4:7], s76 offen sc1 lds
    s_add_u32 s75, s75, 4096
    s_and_b32 s75, s75, 0x1ffff
    s_add_u32 m0, s74, 115584
    s_add_u32 s76, s70, s75
    buffer_load_dwordx4 v3, s[4:7], s76 offen sc1 lds
    s_add_u32 s75, s75, 4096
    s_and_b32 s75, s75, 0x1ffff
    s_add_u32 m0, s74, 119712
    s_add_u32 s76, s70, s75
    buffer_load_dwordx4 v3, s[4:7], s76 offen sc1 lds
    s_add_u32 s75, s75, 4096
    s_and_b32 s75, s75, 0x1ffff
    s_add_u32 m0, s74, 123840
    s_add_u32 s76, s70, s75
    buffer_load_dwordx4 v3, s[4:7], s76 offen sc1 lds
    s_add_u32 s75, s75, 4096
    s_and_b32 s75, s75, 0x1ffff
    s_add_u32 m0, s74, 127968
    s_add_u32 s76, s70, s75
    buffer_load_dwordx4 v3, s[4:7], s76 offen sc1 lds
    s_add_u32 s75, s75, 4096
    s_waitcnt vmcnt(0) lgkmcnt(0)
    v_mov_b32 v28, 163280
    v_mov_b32 v29, 1
    s_mov_b64 exec, 1
    ds_add_u32 v28, v29 offset:36
    s_mov_b64 exec, -1
    v_cvt_pk_bf16_f32 v48, v32, v33
    v_cvt_pk_bf16_f32 v49, v34, v35
    v_cvt_pk_bf16_f32 v50, v36, v37
    v_cvt_pk_bf16_f32 v51, v38, v39
    v_cvt_pk_bf16_f32 v52, v40, v41
    v_cvt_pk_bf16_f32 v53, v42, v43
    v_cvt_pk_bf16_f32 v54, v44, v45
    v_cvt_pk_bf16_f32 v55, v46, v47
    ds_write_b64 v160, v[48:49] offset:0
    ds_write_b64 v160, v[50:51] offset:16
    ds_write_b64 v160, v[52:53] offset:32
    ds_write_b64 v160, v[54:55] offset:48
    s_waitcnt lgkmcnt(0)
    ds_read_b128 v[128:131], v161
    ds_read_b128 v[132:135], v161 offset:1280
    s_waitcnt lgkmcnt(1)
    buffer_store_dwordx4 v[128:131], v3, s[4:7], s77 offen sc1
    s_waitcnt lgkmcnt(0)
    buffer_store_dwordx4 v[132:135], v3, s[4:7], s77 offen offset:1024 sc1
    s_lshl_b32 s78, s64, 2
    s_add_u32 s78, s78, 0xc01000
    s_waitcnt vmcnt(0)
    v_mov_b32 v28, 163280
    v_mov_b32 v29, 1
    s_mov_b64 exec, 1
    ds_add_rtn_u32 v29, v28, v29 offset:16
    ds_read_b64 v[30:31], v28
    v_mov_b32 v32, s78
    s_waitcnt lgkmcnt(0)
    v_cmp_eq_u32 vcc, 3, v29
    s_cbranch_vccz sig_96
    buffer_store_dwordx2 v[30:31], v32, s[4:7], 0 offen sc1
sig_96:
    s_mov_b64 exec, -1
    s_lshl_b32 s76, s68, 15
    s_lshl_b32 s78, s69, 6
    s_add_u32 s76, s76, s78
    s_add_u32 s78, s76, 0x4000
    buffer_load_dwordx4 v[144:147], v11, s[8:11], s76 offen
    buffer_load_dwordx4 v[148:151], v11, s[8:11], s78 offen
    s_lshl_b32 s78, s69, 7
    s_add_u32 s78, s78, 0xc01000
    v_mov_b32 v28, 163280
    s_mov_b32 s79, 0
lw_97:
    ds_read_b32 v29, v28 offset:16
    s_add_u32 s79, s79, 1
    s_waitcnt lgkmcnt(0)
    v_cmp_le_u32 vcc, 4, v29
    s_cmp_gt_u32 s79, 480000
    s_cbranch_scc1 lg_98
    s_cbranch_vccnz lg_98
    s_sleep 8
    s_branch lw_97
lg_98:
    v_and_b32 v30, 15, v2
    v_lshlrev_b32 v30, 3, v30
    s_mov_b32 s79, 0
poll_99:
    buffer_load_dwordx2 v[28:29], v30, s[4:7], s78 offen sc1
    s_add_u32 s79, s79, 1
    s_waitcnt vmcnt(0)
    v_cmp_eq_u64 vcc, s[60:61], v[28:29]
    s_cmp_gt_u32 s79, 30000
    s_cbranch_scc1 pgo_100
    s_cmp_eq_u64 vcc, exec
    s_cbranch_scc1 pgo_100
    s_sleep 8
    s_branch poll_99
pgo_100:
    s_mul_i32 s77, s3, 4608
    s_add_u32 s77, s77, 132096
    s_lshl_b32 s70, s69, 17
    s_lshl_b32 s71, s68, 6
    s_add_u32 s70, s70, s71
    s_add_u32 s70, s70, 0xa00000
    s_add_u32 s71, s70, 0x10000
    s_mov_b32 m0, s77
    s_nop 0
    buffer_load_dwordx4 v10, s[4:7], s70 offen sc1 lds
    s_add_u32 m0, s77, 1024
    s_nop 0
    buffer_load_dwordx4 v10, s[4:7], s71 offen sc1 lds
    s_lshl_b32 s70, s68, 16
    s_lshl_b32 s71, s69, 6
    s_add_u32 s70, s70, s71
    s_add_u32 s71, s70, 0x8000
    s_waitcnt vmcnt(0)
    ds_read_b64_tr_b16 v[28:29], v13
    ds_read_b64_tr_b16 v[30:31], v13 offset:256
    ds_read_b64_tr_b16 v[32:33], v13 offset:32
    ds_read_b64_tr_b16 v[34:35], v13 offset:288
    s_waitcnt lgkmcnt(2)
    ds_write_b128 v14, v[28:31]
    s_waitcnt lgkmcnt(1)
    ds_write_b128 v14, v[32:35] offset:1280
    s_waitcnt lgkmcnt(0)
    ds_read_b128 v[28:31], v15
    ds_read_b128 v[32:35], v15 offset:1280
    s_waitcnt lgkmcnt(0)
    v_lshlrev_b32 v36, 16, v144
    v_and_b32 v37, 0xffff0000, v144
    v_lshlrev_b32 v38, 16, v28
    v_and_b32 v39, 0xffff0000, v28
    v_pk_mul_f32 v[36:37], v[36:37], v[38:39]
    v_cvt_pk_bf16_f32 v40, v36, v37
    v_lshlrev_b32 v36, 16, v145
    v_and_b32 v37, 0xffff0000, v145
    v_lshlrev_b32 v38, 16, v29
    v_and_b32 v39, 0xffff0000, v29
    v_pk_mul_f32 v[36:37], v[36:37], v[38:39]
    v_cvt_pk_bf16_f32 v41, v36, v37
    v_lshlrev_b32 v36, 16, v146
    v_and_b32 v37, 0xffff0000, v146
    v_lshlrev_b32 v38, 16, v30
    v_and_b32 v39, 0xffff0000, v30
    v_pk_mul_f32 v[36:37], v[36:37], v[38:39]
    v_cvt_pk_bf16_f32 v42, v36, v37
    v_lshlrev_b32 v36, 16, v147
    v_and_b32 v37, 0xffff0000, v147
    v_lshlrev_b32 v38, 16, v31
    v_and_b32 v39, 0xffff0000, v31
    v_pk_mul_f32 v[36:37], v[36:37], v[38:39]
    v_cvt_pk_bf16_f32 v43, v36, v37
    v_lshlrev_b32 v36, 16, v148
    v_and_b32 v37, 0xffff0000, v148
    v_lshlrev_b32 v38, 16, v32
    v_and_b32 v39, 0xffff0000, v32
    v_pk_mul_f32 v[36:37], v[36:37], v[38:39]
    v_cvt_pk_bf16_f32 v44, v36, v37
    v_lshlrev_b32 v36, 16, v149
    v_and_b32 v37, 0xffff0000, v149
    v_lshlrev_b32 v38, 16, v33
    v_and_b32 v39, 0xffff0000, v33
    v_pk_mul_f32 v[36:37], v[36:37], v[38:39]
    v_cvt_pk_bf16_f32 v45, v36, v37
    v_lshlrev_b32 v36, 16, v150
    v_and_b32 v37, 0xffff0000, v150
    v_lshlrev_b32 v38, 16, v34
    v_and_b32 v39, 0xffff0000, v34
    v_pk_mul_f32 v[36:37], v[36:37], v[38:39]
    v_cvt_pk_bf16_f32 v46, v36, v37
    v_lshlrev_b32 v36, 16, v151
    v_and_b32 v37, 0xffff0000, v151
    v_lshlrev_b32 v38, 16, v35
    v_and_b32 v39, 0xffff0000, v35
    v_pk_mul_f32 v[36:37], v[36:37], v[38:39]
    v_cvt_pk_bf16_f32 v47, v36, v37
    buffer_store_dwordx4 v[40:43], v162, s[32:35], s70 offen sc1
    buffer_store_dwordx4 v[44:47], v162, s[32:35], s71 offen sc1
    s_lshl_b32 s64, s62, 2
    s_and_b32 s65, s63, 3
    s_add_u32 s64, s64, s65
    s_lshr_b32 s65, s63, 2
    s_lshl_b32 s70, s3, 14
    v_mov_b32 v28, 163280
    s_mov_b32 s79, 0
lw_101:
    ds_read_b32 v29, v28 offset:56
    s_add_u32 s79, s79, 1
    s_waitcnt lgkmcnt(0)
    v_cmp_le_u32 vcc, 8, v29
    s_cmp_gt_u32 s79, 480000
    s_cbranch_scc1 lg_102
    s_cbranch_vccnz lg_102
    s_sleep 32
    s_branch lw_101
lg_102:
    s_add_u32 m0, s70, 0
    s_mov_b32 s76, 0
    buffer_load_dwordx4 v7, s[12:15], s76 offen lds
    s_add_u32 m0, s70, 1024
    s_mov_b32 s76, 8192
    buffer_load_dwordx4 v7, s[12:15], s76 offen lds
    s_add_u32 m0, s70, 2048
    s_mov_b32 s76, 16384
    buffer_load_dwordx4 v7, s[12:15], s76 offen lds
    s_add_u32 m0, s70, 3072
    s_mov_b32 s76, 24576
    buffer_load_dwordx4 v7, s[12:15], s76 offen lds
    s_add_u32 m0, s70, 4096
    s_mov_b32 s76, 32768
    buffer_load_dwordx4 v7, s[12:15], s76 offen lds
    s_add_u32 m0, s70, 5120
    s_mov_b32 s76, 40960
    buffer_load_dwordx4 v7, s[12:15], s76 offen lds
    s_add_u32 m0, s70, 6144
    s_mov_b32 s76, 49152
    buffer_load_dwordx4 v7, s[12:15], s76 offen lds
    s_add_u32 m0, s70, 7168
    s_mov_b32 s76, 57344
    buffer_load_dwordx4 v7, s[12:15], s76 offen lds
    s_add_u32 m0, s70, 8192
    s_mov_b32 s76, 65536
    buffer_load_dwordx4 v7, s[12:15], s76 offen lds
    s_add_u32 m0, s70, 9216
    s_mov_b32 s76, 73728
    buffer_load_dwordx4 v7, s[12:15], s76 offen lds
    s_add_u32 m0, s70, 10240
    s_mov_b32 s76, 81920
    buffer_load_dwordx4 v7, s[12:15], s76 offen lds
    s_add_u32 m0, s70, 11264
    s_mov_b32 s76, 90112
    buffer_load_dwordx4 v7, s[12:15], s76 offen lds
    s_add_u32 m0, s70, 12288
    s_mov_b32 s76, 98304
    buffer_load_dwordx4 v7, s[12:15], s76 offen lds
    s_add_u32 m0, s70, 13312
    s_mov_b32 s76, 106496
    buffer_load_dwordx4 v7, s[12:15], s76 offen lds
    s_add_u32 m0, s70, 14336
    s_mov_b32 s76, 114688
    buffer_load_dwordx4 v7, s[12:15], s76 offen lds
    s_add_u32 m0, s70, 15360
    s_mov_b32 s76, 122880
    buffer_load_dwordx4 v7, s[12:15], s76 offen lds
    s_lshl_b32 s70, s64, 1
    s_add_u32 s70, s70, s72
    s_lshl_b32 s70, s70, 15
    s_lshl_b32 s71, s73, 12
    s_add_u32 s70, s70, s71
    s_add_u32 s70, s70, 0x800000
    s_lshl_b32 s75, s72, 15
    s_add_u32 s75, s75, s71
    s_add_u32 s75, s75, 66560
    s_lshl_b32 s66, s64, 1
    s_add_u32 s66, s66, s73
    s_lshl_b32 s66, s66, 16
    s_lshl_b32 s67, s65, 7
    s_add_u32 s66, s66, s67
    s_lshl_b32 s67, s72, 6
    s_add_u32 s66, s66, s67
    s_add_u32 s66, s66, 1024
    s_add_u32 s67, s66, 0x8000
    s_cmp_lg_u32 s3, 0
    s_cbranch_scc1 p3_103
    s_lshr_b32 s78, s64, 2
    s_lshl_b32 s78, s78, 8
    s_add_u32 s78, s78, 0xc01800
    v_mov_b32 v100, 163280
    s_mov_b32 s79, 0
lw_104:
    ds_read_b32 v101, v100 offset:20
    s_add_u32 s79, s79, 1
    s_waitcnt lgkmcnt(0)
    v_cmp_le_u32 vcc, 1, v101
    s_cmp_gt_u32 s79, 480000
    s_cbranch_scc1 lg_105
    s_cbranch_vccnz lg_105
    s_sleep 16
    s_branch lw_104
lg_105:
    v_mov_b32 v100, 163280
    s_mov_b32 s79, 0
lw_106:
    ds_read_b32 v101, v100 offset:20
    s_add_u32 s79, s79, 1
    s_waitcnt lgkmcnt(0)
    v_cmp_le_u32 vcc, 8, v101
    s_cmp_gt_u32 s79, 480000
    s_cbranch_scc1 lg_107
    s_cbranch_vccnz lg_107
    s_sleep 2
    s_branch lw_106
lg_107:
    s_waitcnt vmcnt(0)
    v_and_b32 v102, 31, v2
    v_lshlrev_b32 v102, 3, v102
    s_mov_b32 s79, 0
poll_108:
    buffer_load_dwordx2 v[100:101], v102, s[4:7], s78 offen sc1
    s_add_u32 s79, s79, 1
    s_waitcnt vmcnt(0)
    v_cmp_eq_u64 vcc, s[60:61], v[100:101]
    s_cmp_gt_u32 s79, 30000
    s_cbranch_scc1 pgo_109
    s_cmp_eq_u64 vcc, exec
    s_cbranch_scc1 pgo_109
    s_sleep 1
    s_branch poll_108
pgo_109:
    s_branch p4_110
p3_103:
    s_waitcnt vmcnt(0)
p4_110:
    s_barrier
    s_add_u32 m0, s75, 0
    s_add_u32 s76, s70, 0
    buffer_load_dwordx4 v3, s[4:7], s76 offen sc1 lds
    s_add_u32 m0, s75, 1024
    s_add_u32 s76, s70, 1024
    buffer_load_dwordx4 v3, s[4:7], s76 offen sc1 lds
    s_add_u32 m0, s75, 2048
    s_add_u32 s76, s70, 2048
    buffer_load_dwordx4 v3, s[4:7], s76 offen sc1 lds
    s_add_u32 m0, s75, 3072
    s_add_u32 s76, s70, 3072
    buffer_load_dwordx4 v3, s[4:7], s76 offen sc1 lds
    s_add_u32 m0, s75, 8192
    s_add_u32 s76, s70, 8192
    buffer_load_dwordx4 v3, s[4:7], s76 offen sc1 lds
    s_add_u32 m0, s75, 9216
    s_add_u32 s76, s70, 9216
    buffer_load_dwordx4 v3, s[4:7], s76 offen sc1 lds
    s_add_u32 m0, s75, 10240
    s_add_u32 s76, s70, 10240
    buffer_load_dwordx4 v3, s[4:7], s76 offen sc1 lds
    s_add_u32 m0, s75, 11264
    s_add_u32 s76, s70, 11264
    buffer_load_dwordx4 v3, s[4:7], s76 offen sc1 lds
    s_add_u32 m0, s75, 16384
    s_add_u32 s76, s70, 16384
    buffer_load_dwordx4 v3, s[4:7], s76 offen sc1 lds
    s_add_u32 m0, s75, 17408
    s_add_u32 s76, s70, 17408
    buffer_load_dwordx4 v3, s[4:7], s76 offen sc1 lds
    s_add_u32 m0, s75, 18432
    s_add_u32 s76, s70, 18432
    buffer_load_dwordx4 v3, s[4:7], s76 offen sc1 lds
    s_add_u32 m0, s75, 19456
    s_add_u32 s76, s70, 19456
    buffer_load_dwordx4 v3, s[4:7], s76 offen sc1 lds
    s_add_u32 m0, s75, 24576
    s_add_u32 s76, s70, 24576
    buffer_load_dwordx4 v3, s[4:7], s76 offen sc1 lds
    s_add_u32 m0, s75, 25600
    s_add_u32 s76, s70, 25600
    buffer_load_dwordx4 v3, s[4:7], s76 offen sc1 lds
    s_add_u32 m0, s75, 26624
    s_add_u32 s76, s70, 26624
    buffer_load_dwordx4 v3, s[4:7], s76 offen sc1 lds
    s_add_u32 m0, s75, 27648
    s_add_u32 s76, s70, 27648
    buffer_load_dwordx4 v3, s[4:7], s76 offen sc1 lds
    s_waitcnt vmcnt(12)
    s_barrier
    ds_read_b128 v[44:47], v164 offset:0
    ds_read_b64_tr_b16 v[40:41], v163 offset:0
    ds_read_b64_tr_b16 v[42:43], v163 offset:1024
    ds_read_b128 v[52:55], v164 offset:1024
    ds_read_b64_tr_b16 v[48:49], v163 offset:2048
    ds_read_b64_tr_b16 v[50:51], v163 offset:3072
    ds_read_b128 v[60:63], v164 offset:2048
    ds_read_b64_tr_b16 v[56:57], v163 offset:4096
    ds_read_b64_tr_b16 v[58:59], v163 offset:5120
    ds_read_b128 v[68:71], v164 offset:3072
    ds_read_b64_tr_b16 v[64:65], v163 offset:6144
    ds_read_b64_tr_b16 v[66:67], v163 offset:7168
    ds_read_b128 v[76:79], v164 offset:4096
    ds_read_b64_tr_b16 v[72:73], v163 offset:8192
    ds_read_b64_tr_b16 v[74:75], v163 offset:9216
    s_waitcnt lgkmcnt(12)
    v_mfma_f32_32x32x16_bf16 v[80:95], v[40:43], v[44:47], 0
    ds_read_b128 v[44:47], v164 offset:5120
    ds_read_b64_tr_b16 v[40:41], v163 offset:10240
    ds_read_b64_tr_b16 v[42:43], v163 offset:11264
    s_waitcnt lgkmcnt(12)
    v_mfma_f32_32x32x16_bf16 v[80:95], v[48:51], v[52:55], v[80:95]
    ds_read_b128 v[52:55], v164 offset:6144
    ds_read_b64_tr_b16 v[48:49], v163 offset:12288
    ds_read_b64_tr_b16 v[50:51], v163 offset:13312
    s_waitcnt lgkmcnt(12)
    v_mfma_f32_32x32x16_bf16 v[80:95], v[56:59], v[60:63], v[80:95]
    ds_read_b128 v[60:63], v164 offset:7168
    ds_read_b64_tr_b16 v[56:57], v163 offset:14336
    ds_read_b64_tr_b16 v[58:59], v163 offset:15360
    s_waitcnt lgkmcnt(12)
    v_mfma_f32_32x32x16_bf16 v[80:95], v[64:67], v[68:71], v[80:95]
    s_waitcnt vmcnt(8)
    s_barrier
    ds_read_b128 v[68:71], v164 offset:8192
    ds_read_b64_tr_b16 v[64:65], v163 offset:16384
    ds_read_b64_tr_b16 v[66:67], v163 offset:17408
    s_waitcnt lgkmcnt(12)
    v_mfma_f32_32x32x16_bf16 v[80:95], v[72:75], v[76:79], v[80:95]
    ds_read_b128 v[76:79], v164 offset:9216
    ds_read_b64_tr_b16 v[72:73], v163 offset:18432
    ds_read_b64_tr_b16 v[74:75], v163 offset:19456
    s_waitcnt lgkmcnt(12)
    v_mfma_f32_32x32x16_bf16 v[80:95], v[40:43], v[44:47], v[80:95]
    ds_read_b128 v[44:47], v164 offset:10240
    ds_read_b64_tr_b16 v[40:41], v163 offset:20480
    ds_read_b64_tr_b16 v[42:43], v163 offset:21504
    s_waitcnt lgkmcnt(12)
    v_mfma_f32_32x32x16_bf16 v[80:95], v[48:51], v[52:55], v[80:95]
    ds_read_b128 v[52:55], v164 offset:11264
    ds_read_b64_tr_b16 v[48:49], v163 offset:22528
    ds_read_b64_tr_b16 v[50:51], v163 offset:23552
    s_waitcnt lgkmcnt(12)
    v_mfma_f32_32x32x16_bf16 v[80:95], v[56:59], v[60:63], v[80:95]
    ds_read_b128 v[60:63], v164 offset:12288
    ds_read_b64_tr_b16 v[56:57], v163 offset:24576
    ds_read_b64_tr_b16 v[58:59], v163 offset:25600
    s_waitcnt lgkmcnt(12)
    v_mfma_f32_32x32x16_bf16 v[80:95], v[64:67], v[68:71], v[80:95]
    ds_read_b128 v[68:71], v164 offset:13312
    ds_read_b64_tr_b16 v[64:65], v163 offset:26624
    ds_read_b64_tr_b16 v[66:67], v163 offset:27648
    s_waitcnt lgkmcnt(12)
    v_mfma_f32_32x32x16_bf16 v[80:95], v[72:75], v[76:79], v[80:95]
    ds_read_b128 v[76:79], v164 offset:14336
    ds_read_b64_tr_b16 v[72:73], v163 offset:28672
    ds_read_b64_tr_b16 v[74:75], v163 offset:29696
    s_waitcnt lgkmcnt(12)
    v_mfma_f32_32x32x16_bf16 v[80:95], v[40:43], v[44:47], v[80:95]
    ds_read_b128 v[44:47], v164 offset:15360
    ds_read_b64_tr_b16 v[40:41], v163 offset:30720
    ds_read_b64_tr_b16 v[42:43], v163 offset:31744
    s_waitcnt lgkmcnt(12)
    v_mfma_f32_32x32x16_bf16 v[80:95], v[48:51], v[52:55], v[80:95]
    s_waitcnt vmcnt(4)
    s_barrier
    ds_read_b128 v[52:55], v164 offset:16384
    ds_read_b64_tr_b16 v[48:49], v163 offset:32768
    ds_read_b64_tr_b16 v[50:51], v163 offset:33792
    s_waitcnt lgkmcnt(12)
    v_mfma_f32_32x32x16_bf16 v[80:95], v[56:59], v[60:63], v[80:95]
    ds_read_b128 v[60:63], v164 offset:17408
    ds_read_b64_tr_b16 v[56:57], v163 offset:34816
    ds_read_b64_tr_b16 v[58:59], v163 offset:35840
    s_waitcnt lgkmcnt(12)
    v_mfma_f32_32x32x16_bf16 v[80:95], v[64:67], v[68:71], v[80:95]
    ds_read_b128 v[68:71], v164 offset:18432
    ds_read_b64_tr_b16 v[64:65], v163 offset:36864
    ds_read_b64_tr_b16 v[66:67], v163 offset:37888
    s_waitcnt lgkmcnt(12)
    v_mfma_f32_32x32x16_bf16 v[80:95], v[72:75], v[76:79], v[80:95]
    ds_read_b128 v[76:79], v164 offset:19456
    ds_read_b64_tr_b16 v[72:73], v163 offset:38912
    ds_read_b64_tr_b16 v[74:75], v163 offset:39936
    s_waitcnt lgkmcnt(12)
    v_mfma_f32_32x32x16_bf16 v[80:95], v[40:43], v[44:47], v[80:95]
    ds_read_b128 v[44:47], v164 offset:20480
    ds_read_b64_tr_b16 v[40:41], v163 offset:40960
    ds_read_b64_tr_b16 v[42:43], v163 offset:41984
    s_waitcnt lgkmcnt(12)
    v_mfma_f32_32x32x16_bf16 v[80:95], v[48:51], v[52:55], v[80:95]
    ds_read_b128 v[52:55], v164 offset:21504
    ds_read_b64_tr_b16 v[48:49], v163 offset:43008
    ds_read_b64_tr_b16 v[50:51], v163 offset:44032
    s_waitcnt lgkmcnt(12)
    v_mfma_f32_32x32x16_bf16 v[80:95], v[56:59], v[60:63], v[80:95]
    ds_read_b128 v[60:63], v164 offset:22528
    ds_read_b64_tr_b16 v[56:57], v163 offset:45056
    ds_read_b64_tr_b16 v[58:59], v163 offset:46080
    s_waitcnt lgkmcnt(12)
    v_mfma_f32_32x32x16_bf16 v[80:95], v[64:67], v[68:71], v[80:95]
    ds_read_b128 v[68:71], v164 offset:23552
    ds_read_b64_tr_b16 v[64:65], v163 offset:47104
    ds_read_b64_tr_b16 v[66:67], v163 offset:48128
    s_waitcnt lgkmcnt(12)
    v_mfma_f32_32x32x16_bf16 v[80:95], v[72:75], v[76:79], v[80:95]
    s_waitcnt vmcnt(0)
    s_barrier
    ds_read_b128 v[76:79], v164 offset:24576
    ds_read_b64_tr_b16 v[72:73], v163 offset:49152
    ds_read_b64_tr_b16 v[74:75], v163 offset:50176
    s_waitcnt lgkmcnt(12)
    v_mfma_f32_32x32x16_bf16 v[80:95], v[40:43], v[44:47], v[80:95]
    ds_read_b128 v[44:47], v164 offset:25600
    ds_read_b64_tr_b16 v[40:41], v163 offset:51200
    ds_read_b64_tr_b16 v[42:43], v163 offset:52224
    s_waitcnt lgkmcnt(12)
    v_mfma_f32_32x32x16_bf16 v[80:95], v[48:51], v[52:55], v[80:95]
    ds_read_b128 v[52:55], v164 offset:26624
    ds_read_b64_tr_b16 v[48:49], v163 offset:53248
    ds_read_b64_tr_b16 v[50:51], v163 offset:54272
    s_waitcnt lgkmcnt(12)
    v_mfma_f32_32x32x16_bf16 v[80:95], v[56:59], v[60:63], v[80:95]
    ds_read_b128 v[60:63], v164 offset:27648
    ds_read_b64_tr_b16 v[56:57], v163 offset:55296
    ds_read_b64_tr_b16 v[58:59], v163 offset:56320
    s_waitcnt lgkmcnt(12)
    v_mfma_f32_32x32x16_bf16 v[80:95], v[64:67], v[68:71], v[80:95]
    ds_read_b128 v[68:71], v164 offset:28672
    ds_read_b64_tr_b16 v[64:65], v163 offset:57344
    ds_read_b64_tr_b16 v[66:67], v163 offset:58368
    s_waitcnt lgkmcnt(12)
    v_mfma_f32_32x32x16_bf16 v[80:95], v[72:75], v[76:79], v[80:95]
    ds_read_b128 v[76:79], v164 offset:29696
    ds_read_b64_tr_b16 v[72:73], v163 offset:59392
    ds_read_b64_tr_b16 v[74:75], v163 offset:60416
    s_waitcnt lgkmcnt(12)
    v_mfma_f32_32x32x16_bf16 v[80:95], v[40:43], v[44:47], v[80:95]
    ds_read_b128 v[44:47], v164 offset:30720
    ds_read_b64_tr_b16 v[40:41], v163 offset:61440
    ds_read_b64_tr_b16 v[42:43], v163 offset:62464
    s_waitcnt lgkmcnt(12)
    v_mfma_f32_32x32x16_bf16 v[80:95], v[48:51], v[52:55], v[80:95]
    ds_read_b128 v[52:55], v164 offset:31744
    ds_read_b64_tr_b16 v[48:49], v163 offset:63488
    ds_read_b64_tr_b16 v[50:51], v163 offset:64512
    s_waitcnt lgkmcnt(12)
    v_mfma_f32_32x32x16_bf16 v[80:95], v[56:59], v[60:63], v[80:95]
    s_waitcnt lgkmcnt(9)
    v_mfma_f32_32x32x16_bf16 v[80:95], v[64:67], v[68:71], v[80:95]
    s_waitcnt lgkmcnt(6)
    v_mfma_f32_32x32x16_bf16 v[80:95], v[72:75], v[76:79], v[80:95]
    s_waitcnt lgkmcnt(3)
    v_mfma_f32_32x32x16_bf16 v[80:95], v[40:43], v[44:47], v[80:95]
    s_waitcnt lgkmcnt(0)
    v_mfma_f32_32x32x16_bf16 v[80:95], v[48:51], v[52:55], v[80:95]
    s_nop 11
    v_cvt_pk_bf16_f32 v32, v80, v81
    v_cvt_pk_bf16_f32 v33, v82, v83
    v_cvt_pk_bf16_f32 v34, v84, v85
    v_cvt_pk_bf16_f32 v35, v86, v87
    v_cvt_pk_bf16_f32 v36, v88, v89
    v_cvt_pk_bf16_f32 v37, v90, v91
    v_cvt_pk_bf16_f32 v38, v92, v93
    v_cvt_pk_bf16_f32 v39, v94, v95
    ds_write_b64 v160, v[32:33] offset:0
    ds_write_b64 v160, v[34:35] offset:16
    ds_write_b64 v160, v[36:37] offset:32
    ds_write_b64 v160, v[38:39] offset:48
    s_waitcnt lgkmcnt(0)
    ds_read_b128 v[40:43], v161
    ds_read_b128 v[44:47], v161 offset:1280
    s_waitcnt lgkmcnt(1)
    buffer_store_dwordx4 v[40:43], v162, s[32:35], s66 offen sc1
    s_waitcnt lgkmcnt(0)
    buffer_store_dwordx4 v[44:47], v162, s[32:35], s67 offen sc1
end_1:
    s_endpgm
.section .rodata,"a"
.p2align 6
.amdhsa_kernel concat_heads__ssm_conv_h3__softmax_full_mha__prompt_kernel
  .amdhsa_next_free_vgpr 168
  .amdhsa_next_free_sgpr 84
  .amdhsa_accum_offset 168
  .amdhsa_group_segment_fixed_size 0
  .amdhsa_kernarg_size 96
  .amdhsa_user_sgpr_count 2
  .amdhsa_user_sgpr_kernarg_segment_ptr 1
  .amdhsa_system_sgpr_workgroup_id_x 1
.end_amdhsa_kernel
```
